```python
import torch

def _softmax(x, axis=-1):
    return torch.softmax(x, dim=axis)

def _gelu(x):
    return torch.nn.functional.gelu(x, approximate='tanh')

def _silu(x):
    return torch.nn.functional.silu(x)

def _sigmoid(x):
    return torch.sigmoid(x)

def _layernorm(x, axis=-1, eps=1e-05):
    m = x.mean(dim=axis, keepdim=True)
    v = x.var(dim=axis, keepdim=True, unbiased=False)
    return (x - m) / torch.sqrt(v + eps)

def _scatter_add(tgt, idx, src, axis=0):
    return tgt.clone().index_add_(axis, idx, src)

def _segment_sum(src, seg, n):
    out = torch.zeros((n,) + src.shape[1:], dtype=src.dtype)
    return out.index_add_(0, seg, src)

def _pad(x, pw):
    flat = tuple((v for pair in reversed(pw) for v in pair))
    return torch.nn.functional.pad(x, flat)
kernel_name = 'adaLN_cond__ssm_conv_s4__dense_activation_silu__prompt'

def setup_inputs():

    _w = lambda a: (lambda t: t.to(torch.bfloat16) if t.is_floating_point() else t)(torch.as_tensor(a))

    def _A_setup():
        B, L, D, N = (1, 2048, 448, 256)
        A_re = -(lambda _x: torch.exp(torch.as_tensor(_x)))((lambda *s: torch.randn(*s, dtype=torch.bfloat16) * 3.2)(D, N))
        A_im = torch.pi * (lambda *s: torch.randn(*s, dtype=torch.bfloat16) * 0.05)(D, N)
        B_re = (lambda *s: torch.randn(*s, dtype=torch.bfloat16) * 0.1)(D, N)
        B_im = (lambda *s: torch.randn(*s, dtype=torch.bfloat16) * 0.1)(D, N)
        C_re = (lambda *s: torch.randn(*s, dtype=torch.bfloat16) * 0.1)(D, N)
        C_im = (lambda *s: torch.randn(*s, dtype=torch.bfloat16) * 0.1)(D, N)
        log_dt = (lambda *s: torch.randn(*s, dtype=torch.bfloat16) * 0.05)(D) * 0.5 - 4.0
        Dskip = (lambda *s: torch.randn(*s, dtype=torch.bfloat16) * 0.05)(D)
        return {'u': _w((lambda *s: torch.randn(*s, dtype=torch.bfloat16) * 0.05)(B, L, D)), 'A_re': _w(A_re), 'A_im': _w(A_im), 'B_re': _w(B_re), 'B_im': _w(B_im), 'C_re': _w(C_re), 'C_im': _w(C_im), 'log_dt': _w(log_dt), 'Dskip': _w(Dskip)}
    _A_in = _A_setup()

    def _B_setup():
        B, S, D, F = (1, 2048, 448, 1792)
        return {'x': _w((lambda *s: torch.randn(*s, dtype=torch.bfloat16) * 0.05)(B, S, D)), 'w1': _w((lambda *s: torch.randn(*s, dtype=torch.bfloat16) * 3.2)(D, F) * D ** (-0.5)), 'w2': _w((lambda *s: torch.randn(*s, dtype=torch.bfloat16) * 0.4)(F, D) * F ** (-0.5))}
    _B_in = _B_setup()
    return {'A_u': _A_in['u'], 'A_A_re': _A_in['A_re'], 'A_A_im': _A_in['A_im'], 'A_B_re': _A_in['B_re'], 'A_B_im': _A_in['B_im'], 'A_C_re': _A_in['C_re'], 'A_C_im': _A_in['C_im'], 'A_log_dt': _A_in['log_dt'], 'A_Dskip': _A_in['Dskip'], 'B_x': _B_in['x'], 'B_w1': _B_in['w1'], 'B_w2': _B_in['w2'], 'c': _w((lambda *s: torch.randn(*s, dtype=torch.bfloat16) * 0.2)(1, 448) * 8.0), 'w_mod': _w((lambda *s: torch.randn(*s, dtype=torch.bfloat16) * 0.2)(448, 6 * 448) * 448 ** (-0.5) * 8.0)}

def reference(A_u, A_A_re, A_A_im, A_B_re, A_B_im, A_C_re, A_C_im, A_log_dt, A_Dskip, B_x, B_w1, B_w2, c, w_mod):

    def _A_ref(u, A_re, A_im, B_re, B_im, C_re, C_im, log_dt, Dskip):
        Bsz, L, D = u.shape
        dt = torch.exp(log_dt)[:, None]
        A = A_re + 1j * A_im
        Bc = B_re + 1j * B_im
        Cc = C_re + 1j * C_im
        logdA = dt * A
        dB = dt * Bc
        l = (lambda x, dt: x.to(dt))(torch.arange(L), A_re.dtype)
        P = torch.exp(logdA[:, :, None] * l[None, None, :])
        K = torch.einsum('dn,dnl,dn->dl', Cc, P, dB).real
        L2 = 2 * L
        Kp = _pad(K, ((0, 0), (0, L)))
        up = (lambda x, *d: x.permute(*d))(u, 0, 2, 1)
        up = _pad(up, ((0, 0), (0, 0), (0, L)))
        Kf = (lambda x, axes=(-2, -1): torch.fft.rfft2(x.float(), dim=axes))(Kp[:, None, :], axes=(-2, -1))
        Uf = (lambda x, axes=(-2, -1): torch.fft.rfft2(x.float(), dim=axes))(up[:, :, None, :], axes=(-2, -1))
        Yf = Uf * Kf[None, :, :, :]
        y = (lambda x, s, axes=(-2, -1): torch.fft.irfft2(x, s=s, dim=axes).to(torch.bfloat16))(Yf, (1, L2), axes=(-2, -1))[:, :, 0, :L]
        y = (lambda x, *d: x.permute(*d))(y, 0, 2, 1) + u * Dskip[None, None, :]
        return y

    def _B_ref(x, w1, w2):
        h = torch.einsum('bsd,df->bsf', x, w1)
        h = _silu(h)
        out = torch.einsum('bsf,fd->bsd', h, w2)
        return out
    x = A_u
    mod = (_silu(c) @ w_mod).reshape(c.shape[0], 6, 1, -1)
    sa, ca, ga, sb, cb, gb = (mod[:, 0].clone(), mod[:, 1].clone(), mod[:, 2].clone(), mod[:, 3].clone(), mod[:, 4].clone(), mod[:, 5].clone())
    h = _layernorm(x, axis=-1) * (1 + ca) + sa
    x = x + ga * _A_ref(h, A_A_re, A_A_im, A_B_re, A_B_im, A_C_re, A_C_im, A_log_dt, A_Dskip)
    h = _layernorm(x, axis=-1) * (1 + cb) + sb
    x = x + gb * _B_ref(h, B_w1, B_w2)
    return x
```

```asm
; @launch grid=(256,1,1) block=(256,1,1) lds=163840
.amdgcn_target "amdgcn-amd-amdhsa--gfx950"
.text
.globl adaLN_cond__ssm_conv_s4__dense_activation_silu__prompt_kernel
.p2align 8
.type adaLN_cond__ssm_conv_s4__dense_activation_silu__prompt_kernel,@function
adaLN_cond__ssm_conv_s4__dense_activation_silu__prompt_kernel:
  s_cmp_ge_u32 s2, 256
  s_cbranch_scc1 L_end
  s_load_dwordx16 s[16:31], s[0:1], 0
  s_cmp_ge_u32 s2, 32
  s_cbranch_scc1 L_nocpf
  s_getpc_b64 s[14:15]
L_pc:
  v_lshlrev_b32_e64 v2, 7, v0
  v_min_u32 v2, L_codeend-L_pc-4, v2
  global_load_dword v255, v2, s[14:15]
  v_add_u32 v2, 32768, v2
  v_min_u32 v2, L_codeend-L_pc-4, v2
  global_load_dword v254, v2, s[14:15]
L_nocpf:
  s_load_dwordx16 s[32:47], s[0:1], 64
  s_load_dwordx2 s[48:49], s[0:1], 128
  v_lshrrev_b32 v2, 6, v0
  v_and_b32 v1, 63, v0
  v_readfirstlane_b32 s57, v2
  s_and_b32 s52, s2, 7
  s_lshr_b32 s53, s2, 3
  s_mul_i32 s54, s52, 28
  s_add_u32 s54, s54, s53
  s_lshr_b32 s5, s57, 1
  s_and_b32 s3, s57, 1
  s_mul_i32 s6, s53, 37
  s_lshr_b32 s6, s6, 8
  s_mul_i32 s7, s6, 7
  s_sub_u32 s56, s53, s7
  s_lshl_b32 s55, s52, 2
  s_add_u32 s55, s55, s6
  s_cmp_ge_u32 s53, 28
  s_cbranch_scc1 L_spare
  s_lshl_b32 s6, s54, 1
  s_add_u32 s6, s6, s5
  s_lshl_b32 s6, s6, 9
  v_lshl_add_u32 v32, v1, 3, s6
  s_waitcnt lgkmcnt(0)
  global_load_dwordx2 v[208:209], v32, s[18:19]
  global_load_dwordx2 v[210:211], v32, s[20:21]
  s_lshl_b32 s7, s54, 2
  s_load_dword s58, s[30:31], s7
  s_load_dword s59, s[32:33], s7
  s_load_dword s51, s[48:49], 0
  s_cmp_eq_u32 s3, 0
  s_cbranch_scc1 L_noodd
  global_load_dwordx2 v[212:213], v32, s[22:23]
  global_load_dwordx2 v[214:215], v32, s[24:25]
  global_load_dwordx2 v[216:217], v32, s[26:27]
  global_load_dwordx2 v[218:219], v32, s[28:29]
L_noodd:
  v_mov_b32 v56, 0
  v_mov_b32 v57, 0
  v_mov_b32 v58, 0
  v_mov_b32 v59, 0
  v_min_u32_e64 v32, 29, v1
  s_mul_i32 s6, s3, 4608
  s_add_u32 s6, s6, 155296
  v_lshl_add_u32 v32, v32, 4, s6
  ds_write_b128 v32, v[56:59]
  v_and_b32 v32, 1, v1
  v_lshlrev_b32 v32, 4, v32
  v_bfe_u32 v33, v1, 1, 1
  v_mul_u32_u24 v33, 4160, v33
  v_add_u32 v32, v32, v33
  v_bfe_u32 v33, v1, 2, 1
  v_mul_u32_u24 v33, 8320, v33
  v_add_u32 v32, v32, v33
  v_add_u32 v32, 114848, v32
  ds_write_b128 v32, v[56:59]
  v_and_b32_e64 v32, 1, v1
  v_mul_u32_u24 v32, 2304, v32
  v_add_u32 v32, 110304, v32
  ds_write_b64 v32, v[56:57]
  s_mul_i32 s6, s5, 55120
  v_lshl_add_u32 v51, v1, 4, s6
  v_mov_b32 v56, 0x3f80
  v_mov_b32 v57, 0x3f80
  v_mov_b32 v58, 0x3f80
  v_mov_b32 v59, 0x3f80
  ds_write_b128 v51, v[56:59]
  v_lshlrev_b32 v32, 3, v0
  v_add_u32 v40, -1, v32
  v_add_u32 v41, 0, v32
  v_add_u32 v42, 1, v32
  v_add_u32 v43, 2, v32
  v_add_u32 v44, 3, v32
  v_add_u32 v45, 4, v32
  v_add_u32 v46, 5, v32
  v_add_u32 v47, 6, v32
  v_add_u32 v48, 7, v32
  v_max_i32 v40, 0, v40
  v_cvt_f32_u32 v40, v40
  v_cvt_f32_u32 v41, v41
  v_cvt_f32_u32 v42, v42
  v_cvt_f32_u32 v43, v43
  v_cvt_f32_u32 v44, v44
  v_cvt_f32_u32 v45, v45
  v_cvt_f32_u32 v46, v46
  v_cvt_f32_u32 v47, v47
  v_cvt_f32_u32 v48, v48
  v_cvt_pk_bf16_f32 v40, v40, v40
  v_cvt_pk_bf16_f32 v41, v41, v41
  v_cvt_pk_bf16_f32 v42, v42, v42
  v_cvt_pk_bf16_f32 v43, v43, v43
  v_cvt_pk_bf16_f32 v44, v44, v44
  v_cvt_pk_bf16_f32 v45, v45, v45
  v_cvt_pk_bf16_f32 v46, v46, v46
  v_cvt_pk_bf16_f32 v47, v47, v47
  v_cvt_pk_bf16_f32 v48, v48, v48
  v_and_b32 v40, 0xffff0000, v40
  v_and_b32 v41, 0xffff0000, v41
  v_and_b32 v42, 0xffff0000, v42
  v_and_b32 v43, 0xffff0000, v43
  v_and_b32 v44, 0xffff0000, v44
  v_and_b32 v45, 0xffff0000, v45
  v_and_b32 v46, 0xffff0000, v46
  v_and_b32 v47, 0xffff0000, v47
  v_and_b32 v48, 0xffff0000, v48
  v_cvt_u32_f32 v40, v40
  v_cvt_u32_f32 v41, v41
  v_cvt_u32_f32 v42, v42
  v_cvt_u32_f32 v43, v43
  v_cvt_u32_f32 v44, v44
  v_cvt_u32_f32 v45, v45
  v_cvt_u32_f32 v46, v46
  v_cvt_u32_f32 v47, v47
  v_cvt_u32_f32 v48, v48
  v_lshrrev_b32 v32, 8, v40
  v_and_b32 v33, 7, v40
  v_min_u32 v34, 2, v32
  v_lshrrev_b32 v33, v34, v33
  v_lshl_add_u32 v34, v32, 1, 8
  v_add_u32 v35, 12, v32
  v_lshlrev_b32 v32, 3, v32
  v_min3_u32 v34, v34, v35, v32
  v_add_u32 v33, v33, v34
  v_bfe_u32 v34, v40, 3, 5
  v_mul_u32_u24 v34, 72, v34
  v_lshl_add_u32 v40, v33, 1, v34
  v_add_u32 v40, 110240, v40
  v_lshrrev_b32 v32, 8, v41
  v_and_b32 v33, 7, v41
  v_min_u32 v34, 2, v32
  v_lshrrev_b32 v33, v34, v33
  v_lshl_add_u32 v34, v32, 1, 8
  v_add_u32 v35, 12, v32
  v_lshlrev_b32 v32, 3, v32
  v_min3_u32 v34, v34, v35, v32
  v_add_u32_e64 v33, v33, v34
  v_bfe_u32 v34, v41, 3, 5
  v_mul_u32_u24 v34, 72, v34
  v_lshl_add_u32 v41, v33, 1, v34
  v_add_u32 v41, 110240, v41
  v_lshrrev_b32 v32, 8, v42
  v_and_b32 v33, 7, v42
  v_min_u32 v34, 2, v32
  v_lshrrev_b32 v33, v34, v33
  v_lshl_add_u32 v34, v32, 1, 8
  v_add_u32 v35, 12, v32
  v_lshlrev_b32 v32, 3, v32
  v_min3_u32 v34, v34, v35, v32
  v_add_u32_e64 v33, v33, v34
  v_bfe_u32 v34, v42, 3, 5
  v_mul_u32_u24 v34, 72, v34
  v_lshl_add_u32 v42, v33, 1, v34
  v_add_u32 v42, 110240, v42
  v_lshrrev_b32 v32, 8, v43
  v_and_b32 v33, 7, v43
  v_min_u32 v34, 2, v32
  v_lshrrev_b32 v33, v34, v33
  v_lshl_add_u32 v34, v32, 1, 8
  v_add_u32 v35, 12, v32
  v_lshlrev_b32 v32, 3, v32
  v_min3_u32 v34, v34, v35, v32
  v_add_u32_e64 v33, v33, v34
  v_bfe_u32 v34, v43, 3, 5
  v_mul_u32_u24 v34, 72, v34
  v_lshl_add_u32 v43, v33, 1, v34
  v_add_u32 v43, 110240, v43
  s_lshl_b32 s6, s55, 1
  s_add_u32 s6, s6, s5
  s_mul_i32 s6, s6, 28672
  s_lshl_b32 s7, s56, 1
  s_add_u32 s7, s7, s3
  s_lshl_b32 s7, s7, 6
  s_add_u32 s6, s6, s7
  v_lshrrev_b32 v33, 2, v1
  v_mul_u32_u24 v33, 896, v33
  v_and_b32 v34, 3, v1
  v_lshl_add_u32 v33, v34, 4, v33
  v_add_u32 v33, s6, v33
  s_lshl_b32 s7, s57, 11
  s_add_u32 m0, s7, 131584
  v_add_u32 v34, 13312, v33
  global_load_lds_dwordx4 v33, s[16:17]
  global_load_lds_dwordx4 v34, s[16:17] offset:1024
  s_cmp_eq_u32 s3, 0
  s_cbranch_scc1 L_noodd2
  s_lshl_b32 s4, s2, 3
  s_lshl_b32 s6, s5, 2
  s_add_u32 s4, s4, s6
  s_mul_i32 s6, s4, 896
  v_lshrrev_b32 v2, 5, v1
  v_mul_u32_u24 v2, 768, v2
  v_lshl_add_u32 v3, v1, 5, s6
  v_add_u32 v3, v2, v3
  v_mov_b32 v4, 0
  v_mov_b32 v5, 0
  v_mov_b32 v6, 0
  v_mov_b32 v7, 0
  v_mov_b32 v8, 0
  v_mov_b32 v9, 0
  v_mov_b32 v10, 0
  v_mov_b32 v11, 0
  v_mov_b32 v12, 0
  v_mov_b32 v13, 0
  v_mov_b32 v14, 0
  v_mov_b32 v15, 0
  v_mov_b32 v16, 0
  v_mov_b32 v17, 0
  v_mov_b32 v18, 0
  v_mov_b32_e64 v19, 0
  s_mov_b32 exec_lo, 0x0fffffff
  s_mov_b32 exec_hi, 0x0fffffff
  global_load_dwordx4 v[4:7], v3, s[16:17]
  global_load_dwordx4 v[8:11], v3, s[16:17] offset:16
  global_load_dwordx4 v[12:15], v3, s[16:17] offset:896
  global_load_dwordx4 v[16:19], v3, s[16:17] offset:912
  s_mov_b64 exec, -1
L_noodd2:
  v_lshrrev_b32 v32, 8, v44
  v_and_b32 v33, 7, v44
  v_min_u32 v34, 2, v32
  v_lshrrev_b32 v33, v34, v33
  v_lshl_add_u32 v34, v32, 1, 8
  v_add_u32 v35, 12, v32
  v_lshlrev_b32 v32, 3, v32
  v_min3_u32 v34, v34, v35, v32
  v_add_u32 v33, v33, v34
  v_bfe_u32 v34, v44, 3, 5
  v_mul_u32_u24 v34, 72, v34
  v_lshl_add_u32 v44, v33, 1, v34
  v_add_u32 v44, 110240, v44
  v_lshrrev_b32 v32, 8, v45
  v_and_b32 v33, 7, v45
  v_min_u32 v34, 2, v32
  v_lshrrev_b32 v33, v34, v33
  v_lshl_add_u32 v34, v32, 1, 8
  v_add_u32 v35, 12, v32
  v_lshlrev_b32 v32, 3, v32
  v_min3_u32 v34, v34, v35, v32
  v_add_u32_e64 v33, v33, v34
  v_bfe_u32 v34, v45, 3, 5
  v_mul_u32_u24 v34, 72, v34
  v_lshl_add_u32 v45, v33, 1, v34
  v_add_u32 v45, 110240, v45
  v_lshrrev_b32 v32, 8, v46
  v_and_b32 v33, 7, v46
  v_min_u32 v34, 2, v32
  v_lshrrev_b32 v33, v34, v33
  v_lshl_add_u32 v34, v32, 1, 8
  v_add_u32 v35, 12, v32
  v_lshlrev_b32 v32, 3, v32
  v_min3_u32 v34, v34, v35, v32
  v_add_u32_e64 v33, v33, v34
  v_bfe_u32 v34, v46, 3, 5
  v_mul_u32_u24 v34, 72, v34
  v_lshl_add_u32 v46, v33, 1, v34
  v_add_u32 v46, 110240, v46
  v_lshrrev_b32 v32, 8, v47
  v_and_b32 v33, 7, v47
  v_min_u32 v34, 2, v32
  v_lshrrev_b32 v33, v34, v33
  v_lshl_add_u32 v34, v32, 1, 8
  v_add_u32 v35, 12, v32
  v_lshlrev_b32 v32, 3, v32
  v_min3_u32 v34, v34, v35, v32
  v_add_u32_e64 v33, v33, v34
  v_bfe_u32 v34, v47, 3, 5
  v_mul_u32_u24 v34, 72, v34
  v_lshl_add_u32 v47, v33, 1, v34
  v_add_u32 v47, 110240, v47
  v_lshrrev_b32 v32, 8, v48
  v_and_b32 v33, 7, v48
  v_min_u32 v34, 2, v32
  v_lshrrev_b32 v33, v34, v33
  v_lshl_add_u32 v34, v32, 1, 8
  v_add_u32 v35, 12, v32
  v_lshlrev_b32 v32, 3, v32
  v_min3_u32 v34, v34, v35, v32
  v_add_u32_e64 v33, v33, v34
  v_bfe_u32 v34, v48, 3, 5
  v_mul_u32_u24 v34, 72, v34
  v_lshl_add_u32 v48, v33, 1, v34
  v_add_u32 v48, 110240, v48
  v_cmp_eq_u32 vcc, 0, v0
  v_mov_b32 v32, 110304
  s_nop 0
  v_cndmask_b32 v40, v40, v32, vcc
  v_lshrrev_b32 v236, 5, v1
  v_bfe_u32 v237, v1, 2, 2
  v_lshl_add_u32 v236, v236, 2, v237
  v_lshlrev_b32 v236, 7, v236
  v_bfe_u32 v238, v1, 4, 1
  v_lshl_add_u32 v236, v238, 5, v236
  v_and_b32 v238, 3, v1
  v_lshl_add_u32 v236, v238, 3, v236
  v_lshrrev_b32 v237, 1, v237
  v_lshl_add_u32 v240, v237, 6, v236
  v_xor_b32 v241, 64, v240
  s_mul_i32 s6, s57, 24576
  v_add_u32 v242, s6, v240
  v_add_u32 v243, s6, v241
  s_lshl_b32 s6, s57, 13
  s_add_u32 s6, s6, 106496
  v_add_u32 v244, s6, v240
  v_add_u32 v245, s6, v241
  v_lshrrev_b32 v236, 3, v1
  v_bfe_u32 v237, v1, 4, 1
  v_lshlrev_b32 v237, 2, v237
  v_and_b32 v238, 7, v1
  v_xor_b32 v237, v237, v238
  v_lshlrev_b32 v237, 4, v237
  v_mul_u32_u24 v238, 3584, v236
  v_add_u32 v246, v237, v238
  v_mul_u32_u24 v238, 896, v236
  v_add_u32 v250, v237, v238
  v_add_u32 v247, 27648, v246
  v_add_u32 v251, 6144, v250
  v_add_u32 v248, 55296, v246
  v_add_u32 v252, 12288, v250
  v_add_u32 v249, 82944, v246
  v_add_u32 v253, 18432, v250
  s_lshl_b32 s6, s56, 9
  s_lshl_b32 s7, s57, 7
  s_add_u32 s6, s6, s7
  s_add_u32 s60, s36, s6
  s_addc_u32 s61, s37, 0
  s_sub_u32 s62, 1605632, s6
  s_mov_b32 s63, 0x20000
  s_mul_i32 s6, s57, 401408
  s_lshl_b32 s7, s56, 7
  s_add_u32 s6, s6, s7
  s_add_u32 s64, s38, s6
  s_addc_u32 s65, s39, 0
  s_sub_u32 s66, 1605632, s6
  s_mov_b32 s67, 0x20000
  v_and_b32 v49, 15, v1
  v_lshrrev_b32_e64 v50, 4, v1
  s_mul_i32 s6, s5, 55120
  v_mul_u32_u24 v52, 1040, v49
  v_lshl_add_u32 v52, v50, 8, v52
  v_add_u32 v52, s6, v52
  s_mul_i32 s7, s3, 16640
  v_add_u32_e64 v53, s7, v52
  s_mul_i32 s6, s5, 2304
  s_mul_i32 s7, s3, 1152
  s_add_u32 s6, s6, s7
  s_add_u32 s6, s6, 110240
  v_mul_u32_u24 v54, 72, v49
  v_lshl_add_u32 v54, v50, 3, v54
  v_add_u32 v54, s6, v54
  v_lshlrev_b32 v55, 4, v0
  v_add_u32 v55, 114880, v55
  v_add_u32 v56, 2, v49
  v_and_b32 v56, 0x1e, v56
  v_lshlrev_b32 v56, 1, v56
  v_lshl_add_u32 v56, v50, 4, v56
  v_and_b32 v57, 1, v49
  v_xor_b32 v57, 1, v57
  v_mul_u32_u24 v57, 4160, v57
  v_add_u32 v56, v56, v57
  s_mul_i32 s6, s5, 8320
  s_lshl_b32 s7, s3, 6
  s_add_u32 s6, s6, s7
  s_add_u32 s6, s6, 114848
  v_add_u32_e64 v56, s6, v56
  v_add_u32 v57, 1024, v56
  v_add_u32 v58, 2048, v56
  v_add_u32 v59, 3072, v56
  s_mul_i32 s6, s5, 4608
  s_add_u32 s6, s6, s7
  s_add_u32 s6, s6, 151680
  v_lshlrev_b32 v60, 5, v49
  v_sub_u32 v60, s6, v60
  v_lshl_add_u32 v60, v50, 4, v60
  v_lshlrev_b32 v61, 4, v0
  v_sub_u32 v61, 155280, v61
  v_lshlrev_b32_e64 v62, 4, v0
  v_add_u32 v62, 2166784, v62
  v_add_u32 v221, 8192, v62
  v_add_u32 v222, 16384, v62
  v_add_u32 v223, 24576, v62
  s_mul_i32 s6, s54, 16640
  s_add_u32 s6, s6, 10485760
  v_lshl_add_u32 v30, v0, 5, s6
  v_add_u32 v31, 8320, v30
  v_lshrrev_b32 v36, 2, v1
  v_bfe_u32 v37, v1, 1, 1
  v_lshl_add_u32 v36, v37, 4, v36
  v_lshlrev_b32 v36, 6, v36
  v_and_b32 v37, 1, v1
  v_lshl_add_u32 v36, v37, 3, v36
  s_lshl_b32 s7, s57, 11
  s_add_u32 s7, s7, 131584
  v_add_u32 v36, s7, v36
  s_lshl_b32 s6, s56, 1
  s_add_u32 s6, s6, s3
  s_mul_i32 s6, s6, 266240
  s_lshl_b32 s7, s55, 1
  s_add_u32 s7, s7, s5
  s_lshl_b32 s7, s7, 7
  s_add_u32 s6, s6, s7
  s_add_u32 s6, s6, 10485760
  v_and_b32 v37, 7, v1
  v_mul_u32_u24 v37, 8320, v37
  v_and_b32 v38, 48, v1
  v_add3_u32 v37, v37, v38, s6
  v_and_b32 v38, 8, v1
  v_lshl_add_u32 v37, v38, 3, v37
  v_and_b32_e64 v63, 1, v1
  v_mul_u32_u24 v63, 7168, v63
  v_bfe_u32 v32, v1, 1, 1
  v_mul_u32_u24 v32, 3584, v32
  s_lshl_b32 s6, s54, 4
  s_add_u32 s6, s6, 4096
  v_add3_u32 v63, v63, v32, s6
  s_mul_i32 s6, s54, 7168
  s_mul_i32 s7, s5, 3584
  s_add_u32 s6, s6, s7
  v_min_u32 v224, 27, v1
  v_lshl_add_u32 v224, v224, 7, s6
  s_lshl_b32 s6, s53, 2
  s_add_u32 s6, s6, s57
  s_lshl_b32 s6, s6, 13
  s_add_u32 s6, s6, 688128
  v_lshl_add_u32 v225, v1, 7, s6
  s_cmp_eq_u32 s3, 0
  s_cbranch_scc1 L_pwave
  s_lshl_b32 s6, s5, 4
  s_waitcnt lgkmcnt(0)
  s_lshr_b32 s6, s58, s6
  s_lshl_b32 s6, s6, 16
  v_mov_b32 v2, s6
  v_mul_f32 v2, 0x3fb8aa3b, v2
  v_exp_f32 v2, v2
  s_waitcnt vmcnt(11)
  v_lshlrev_b32 v64, 16, v208
  s_waitcnt vmcnt(10)
  v_lshlrev_b32 v65, 16, v210
  v_cvt_pk_bf16_f32 v2, v2, v2
  v_and_b32 v2, 0xffff0000, v2
  v_and_b32 v92, 0xffff0000, v208
  v_and_b32 v93, 0xffff0000, v210
  v_lshlrev_b32 v120, 16, v209
  v_lshlrev_b32 v121, 16, v211
  v_and_b32 v148, 0xffff0000, v209
  v_and_b32 v149, 0xffff0000, v211
  v_pk_mul_f32 v[64:65], v[64:65], v[2:3] op_sel_hi:[1,0]
  v_pk_mul_f32 v[92:93], v[92:93], v[2:3] op_sel_hi:[1,0]
  v_pk_mul_f32 v[120:121], v[120:121], v[2:3] op_sel_hi:[1,0]
  v_pk_mul_f32 v[148:149], v[148:149], v[2:3] op_sel_hi:[1,0]
  s_mov_b32 s6, 0x3fb8aa3b
  s_mov_b32 s7, 0x3e22f983
  v_pk_mul_f32 v[64:65], v[64:65], s[6:7]
  v_pk_mul_f32 v[92:93], v[92:93], s[6:7]
  v_pk_mul_f32 v[120:121], v[120:121], s[6:7]
  v_pk_mul_f32 v[148:149], v[148:149], s[6:7]
  v_fract_f32 v85, v65
  v_exp_f32 v84, v64
  v_fract_f32 v113, v93
  v_exp_f32 v112, v92
  v_fract_f32 v141, v121
  v_exp_f32 v140, v120
  v_fract_f32 v169, v149
  v_exp_f32 v168, v148
  v_cos_f32 v68, v85
  v_sin_f32 v69, v85
  v_cos_f32 v96, v113
  v_sin_f32 v97, v113
  v_cos_f32 v124, v141
  v_sin_f32 v125, v141
  v_cos_f32 v152, v169
  v_sin_f32_e64 v153, v169
  v_pk_mul_f32 v[68:69], v[68:69], v[84:85] op_sel:[0,0] op_sel_hi:[1,0]
  v_pk_mul_f32 v[96:97], v[96:97], v[112:113] op_sel:[0,0] op_sel_hi:[1,0]
  v_pk_mul_f32 v[124:125], v[124:125], v[140:141] op_sel:[0,0] op_sel_hi:[1,0]
  v_pk_mul_f32 v[152:153], v[152:153], v[168:169] op_sel:[0,0] op_sel_hi:[1,0]
  s_waitcnt vmcnt(9)
  v_lshlrev_b32 v84, 16, v212
  s_waitcnt vmcnt(8)
  v_lshlrev_b32 v85, 16, v214
  s_waitcnt vmcnt(7)
  v_lshlrev_b32 v80, 16, v216
  s_waitcnt vmcnt(6)
  v_lshlrev_b32 v81, 16, v218
  v_and_b32 v112, 0xffff0000, v212
  v_and_b32 v113, 0xffff0000, v214
  v_and_b32 v108, 0xffff0000, v216
  v_and_b32 v109, 0xffff0000, v218
  v_lshlrev_b32 v140, 16, v213
  v_lshlrev_b32 v141, 16, v215
  v_lshlrev_b32 v136, 16, v217
  v_lshlrev_b32 v137, 16, v219
  v_and_b32 v168, 0xffff0000, v213
  v_and_b32 v169, 0xffff0000, v215
  v_and_b32 v164, 0xffff0000, v217
  v_and_b32 v165, 0xffff0000, v219
  v_pk_mul_f32 v[84:85], v[84:85], v[2:3] op_sel_hi:[1,0]
  v_pk_mul_f32 v[112:113], v[112:113], v[2:3] op_sel_hi:[1,0]
  v_pk_mul_f32 v[140:141], v[140:141], v[2:3] op_sel_hi:[1,0]
  v_pk_mul_f32 v[168:169], v[168:169], v[2:3] op_sel_hi:[1,0]
  v_pk_mul_f32 v[86:87], v[80:81], v[84:85] op_sel:[0,0] op_sel_hi:[1,0]
  v_pk_mul_f32 v[114:115], v[108:109], v[112:113] op_sel:[0,0] op_sel_hi:[1,0]
  v_pk_mul_f32 v[142:143], v[136:137], v[140:141] op_sel:[0,0] op_sel_hi:[1,0]
  v_pk_mul_f32 v[170:171], v[164:165], v[168:169] op_sel:[0,0] op_sel_hi:[1,0]
  v_pk_fma_f32 v[66:67], v[80:81], v[84:85], v[86:87] op_sel:[1,1,0] op_sel_hi:[0,1,1] neg_lo:[1,0,0]
  v_pk_fma_f32 v[94:95], v[108:109], v[112:113], v[114:115] op_sel:[1,1,0] op_sel_hi:[0,1,1] neg_lo:[1,0,0]
  v_pk_fma_f32 v[122:123], v[136:137], v[140:141], v[142:143] op_sel:[1,1,0] op_sel_hi:[0,1,1] neg_lo:[1,0,0]
  v_pk_fma_f32 v[150:151], v[164:165], v[168:169], v[170:171] op_sel:[1,1,0] op_sel_hi:[0,1,1] neg_lo:[1,0,0]
  v_cvt_pk_bf16_f32 v176, v66, -v67
  v_cvt_pk_bf16_f32 v177, v94, -v95
  v_cvt_pk_bf16_f32 v178, v122, -v123
  v_cvt_pk_bf16_f32 v179, v150, -v151
  ds_write_b128 v51, v[176:179] offset:33280
  v_pk_mul_f32 v[86:87], v[66:67], v[68:69] op_sel:[0,0] op_sel_hi:[1,0]
  v_pk_mul_f32 v[114:115], v[94:95], v[96:97] op_sel:[0,0] op_sel_hi:[1,0]
  v_pk_mul_f32 v[142:143], v[122:123], v[124:125] op_sel:[0,0] op_sel_hi:[1,0]
  v_pk_mul_f32 v[170:171], v[150:151], v[152:153] op_sel:[0,0] op_sel_hi:[1,0]
  v_pk_fma_f32 v[78:79], v[66:67], v[68:69], v[86:87] op_sel:[1,1,0] op_sel_hi:[0,1,1] neg_lo:[1,0,0]
  v_pk_fma_f32 v[106:107], v[94:95], v[96:97], v[114:115] op_sel:[1,1,0] op_sel_hi:[0,1,1] neg_lo:[1,0,0]
  v_pk_fma_f32 v[134:135], v[122:123], v[124:125], v[142:143] op_sel:[1,1,0] op_sel_hi:[0,1,1] neg_lo:[1,0,0]
  v_pk_fma_f32 v[162:163], v[150:151], v[152:153], v[170:171] op_sel:[1,1,0] op_sel_hi:[0,1,1] neg_lo:[1,0,0]
  v_cvt_pk_bf16_f32 v180, v78, -v79
  v_cvt_pk_bf16_f32 v181, v106, -v107
  v_cvt_pk_bf16_f32 v182, v134, -v135
  v_cvt_pk_bf16_f32 v183, v162, -v163
  ds_write_b128 v51, v[180:183] offset:34320
  v_pk_mul_f32 v[86:87], v[78:79], v[68:69] op_sel:[0,0] op_sel_hi:[1,0]
  v_pk_mul_f32 v[114:115], v[106:107], v[96:97] op_sel:[0,0] op_sel_hi:[1,0]
  v_pk_mul_f32 v[142:143], v[134:135], v[124:125] op_sel:[0,0] op_sel_hi:[1,0]
  v_pk_mul_f32 v[170:171], v[162:163], v[152:153] op_sel:[0,0] op_sel_hi:[1,0]
  v_pk_fma_f32 v[78:79], v[78:79], v[68:69], v[86:87] op_sel:[1,1,0] op_sel_hi:[0,1,1] neg_lo:[1,0,0]
  v_pk_fma_f32 v[106:107], v[106:107], v[96:97], v[114:115] op_sel:[1,1,0] op_sel_hi:[0,1,1] neg_lo:[1,0,0]
  v_pk_fma_f32 v[134:135], v[134:135], v[124:125], v[142:143] op_sel:[1,1,0] op_sel_hi:[0,1,1] neg_lo:[1,0,0]
  v_pk_fma_f32 v[162:163], v[162:163], v[152:153], v[170:171] op_sel:[1,1,0] op_sel_hi:[0,1,1] neg_lo:[1,0,0]
  v_cvt_pk_bf16_f32 v176, v78, -v79
  v_cvt_pk_bf16_f32 v177, v106, -v107
  v_cvt_pk_bf16_f32 v178, v134, -v135
  v_cvt_pk_bf16_f32 v179, v162, -v163
  ds_write_b128 v51, v[176:179] offset:35360
  v_pk_mul_f32 v[86:87], v[78:79], v[68:69] op_sel:[0,0] op_sel_hi:[1,0]
  v_pk_mul_f32 v[114:115], v[106:107], v[96:97] op_sel:[0,0] op_sel_hi:[1,0]
  v_pk_mul_f32 v[142:143], v[134:135], v[124:125] op_sel:[0,0] op_sel_hi:[1,0]
  v_pk_mul_f32 v[170:171], v[162:163], v[152:153] op_sel:[0,0] op_sel_hi:[1,0]
  v_pk_fma_f32 v[78:79], v[78:79], v[68:69], v[86:87] op_sel:[1,1,0] op_sel_hi:[0,1,1] neg_lo:[1,0,0]
  v_pk_fma_f32 v[106:107], v[106:107], v[96:97], v[114:115] op_sel:[1,1,0] op_sel_hi:[0,1,1] neg_lo:[1,0,0]
  v_pk_fma_f32 v[134:135], v[134:135], v[124:125], v[142:143] op_sel:[1,1,0] op_sel_hi:[0,1,1] neg_lo:[1,0,0]
  v_pk_fma_f32 v[162:163], v[162:163], v[152:153], v[170:171] op_sel:[1,1,0] op_sel_hi:[0,1,1] neg_lo:[1,0,0]
  v_cvt_pk_bf16_f32 v180, v78, -v79
  v_cvt_pk_bf16_f32 v181, v106, -v107
  v_cvt_pk_bf16_f32 v182, v134, -v135
  v_cvt_pk_bf16_f32 v183, v162, -v163
  ds_write_b128 v51, v[180:183] offset:36400
  v_pk_mul_f32 v[86:87], v[78:79], v[68:69] op_sel:[0,0] op_sel_hi:[1,0]
  v_pk_mul_f32 v[114:115], v[106:107], v[96:97] op_sel:[0,0] op_sel_hi:[1,0]
  v_pk_mul_f32 v[142:143], v[134:135], v[124:125] op_sel:[0,0] op_sel_hi:[1,0]
  v_pk_mul_f32 v[170:171], v[162:163], v[152:153] op_sel:[0,0] op_sel_hi:[1,0]
  v_pk_fma_f32 v[78:79], v[78:79], v[68:69], v[86:87] op_sel:[1,1,0] op_sel_hi:[0,1,1] neg_lo:[1,0,0]
  v_pk_fma_f32 v[106:107], v[106:107], v[96:97], v[114:115] op_sel:[1,1,0] op_sel_hi:[0,1,1] neg_lo:[1,0,0]
  v_pk_fma_f32 v[134:135], v[134:135], v[124:125], v[142:143] op_sel:[1,1,0] op_sel_hi:[0,1,1] neg_lo:[1,0,0]
  v_pk_fma_f32 v[162:163], v[162:163], v[152:153], v[170:171] op_sel:[1,1,0] op_sel_hi:[0,1,1] neg_lo:[1,0,0]
  v_cvt_pk_bf16_f32 v176, v78, -v79
  v_cvt_pk_bf16_f32 v177, v106, -v107
  v_cvt_pk_bf16_f32 v178, v134, -v135
  v_cvt_pk_bf16_f32 v179, v162, -v163
  ds_write_b128 v51, v[176:179] offset:37440
  v_pk_mul_f32 v[86:87], v[78:79], v[68:69] op_sel:[0,0] op_sel_hi:[1,0]
  v_pk_mul_f32 v[114:115], v[106:107], v[96:97] op_sel:[0,0] op_sel_hi:[1,0]
  v_pk_mul_f32 v[142:143], v[134:135], v[124:125] op_sel:[0,0] op_sel_hi:[1,0]
  v_pk_mul_f32 v[170:171], v[162:163], v[152:153] op_sel:[0,0] op_sel_hi:[1,0]
  v_pk_fma_f32 v[78:79], v[78:79], v[68:69], v[86:87] op_sel:[1,1,0] op_sel_hi:[0,1,1] neg_lo:[1,0,0]
  v_pk_fma_f32 v[106:107], v[106:107], v[96:97], v[114:115] op_sel:[1,1,0] op_sel_hi:[0,1,1] neg_lo:[1,0,0]
  v_pk_fma_f32 v[134:135], v[134:135], v[124:125], v[142:143] op_sel:[1,1,0] op_sel_hi:[0,1,1] neg_lo:[1,0,0]
  v_pk_fma_f32 v[162:163], v[162:163], v[152:153], v[170:171] op_sel:[1,1,0] op_sel_hi:[0,1,1] neg_lo:[1,0,0]
  v_cvt_pk_bf16_f32 v180, v78, -v79
  v_cvt_pk_bf16_f32 v181, v106, -v107
  v_cvt_pk_bf16_f32 v182, v134, -v135
  v_cvt_pk_bf16_f32 v183, v162, -v163
  ds_write_b128 v51, v[180:183] offset:38480
  v_pk_mul_f32 v[86:87], v[78:79], v[68:69] op_sel:[0,0] op_sel_hi:[1,0]
  v_pk_mul_f32 v[114:115], v[106:107], v[96:97] op_sel:[0,0] op_sel_hi:[1,0]
  v_pk_mul_f32 v[142:143], v[134:135], v[124:125] op_sel:[0,0] op_sel_hi:[1,0]
  v_pk_mul_f32 v[170:171], v[162:163], v[152:153] op_sel:[0,0] op_sel_hi:[1,0]
  v_pk_fma_f32 v[78:79], v[78:79], v[68:69], v[86:87] op_sel:[1,1,0] op_sel_hi:[0,1,1] neg_lo:[1,0,0]
  v_pk_fma_f32 v[106:107], v[106:107], v[96:97], v[114:115] op_sel:[1,1,0] op_sel_hi:[0,1,1] neg_lo:[1,0,0]
  v_pk_fma_f32 v[134:135], v[134:135], v[124:125], v[142:143] op_sel:[1,1,0] op_sel_hi:[0,1,1] neg_lo:[1,0,0]
  s_add_u32 s51, s51, 1
  s_mul_i32 s50, s51, 0x9E3779B1
  s_add_u32 s50, s50, 0x7F4A7C15
  s_waitcnt vmcnt(4)
  ds_read_b64_tr_b16 v[184:185], v36 offset:0
  ds_read_b64_tr_b16 v[188:189], v36 offset:16
  ds_read_b64_tr_b16 v[192:193], v36 offset:32
  ds_read_b64_tr_b16 v[196:197], v36 offset:48
  v_mov_b32 v187, s50
  v_mov_b32 v191, s50
  v_mov_b32 v195, s50
  v_mov_b32 v199, s50
  s_waitcnt lgkmcnt(3)
  v_mov_b32 v186, v185
  v_mov_b32 v185, s50
  global_store_dwordx4 v37, v[184:187], s[48:49] sc1
  v_add_u32 v37, 66560, v37
  s_waitcnt lgkmcnt(2)
  v_mov_b32 v190, v189
  v_mov_b32 v189, s50
  global_store_dwordx4 v37, v[188:191], s[48:49] sc1
  v_add_u32 v37, 66560, v37
  s_waitcnt lgkmcnt(1)
  v_mov_b32 v194, v193
  v_mov_b32 v193, s50
  global_store_dwordx4 v37, v[192:195], s[48:49] sc1
  v_add_u32 v37, 66560, v37
  s_waitcnt lgkmcnt(0)
  v_mov_b32 v198, v197
  v_mov_b32 v197, s50
  global_store_dwordx4 v37, v[196:199], s[48:49] sc1
  v_mov_b32 v2, 0x3f803f80
  s_waitcnt vmcnt(7)
  v_dot2_f32_bf16 v20, v4, v2, 0
  v_dot2_f32_bf16 v21, v4, v4, 0
  s_waitcnt vmcnt(5)
  v_dot2_f32_bf16 v22, v12, v2, 0
  v_dot2_f32_bf16 v23, v12, v12, 0
  v_dot2_f32_bf16 v20, v5, v2, v20
  v_dot2_f32_bf16 v21, v5, v5, v21
  v_dot2_f32_bf16 v22, v13, v2, v22
  v_dot2_f32_bf16 v23, v13, v13, v23
  v_dot2_f32_bf16 v20, v6, v2, v20
  v_dot2_f32_bf16 v21, v6, v6, v21
  v_dot2_f32_bf16 v22, v14, v2, v22
  v_dot2_f32_bf16 v23, v14, v14, v23
  v_dot2_f32_bf16 v20, v7, v2, v20
  v_dot2_f32_bf16 v21, v7, v7, v21
  v_dot2_f32_bf16 v22, v15, v2, v22
  v_dot2_f32_bf16 v23, v15, v15, v23
  v_dot2_f32_bf16 v20, v8, v2, v20
  v_dot2_f32_bf16 v21, v8, v8, v21
  s_waitcnt vmcnt(4)
  s_nop 0
  v_dot2_f32_bf16 v22, v16, v2, v22
  v_dot2_f32_bf16 v23, v16, v16, v23
  v_dot2_f32_bf16 v20, v9, v2, v20
  v_dot2_f32_bf16 v21, v9, v9, v21
  v_dot2_f32_bf16 v22, v17, v2, v22
  v_dot2_f32_bf16 v23, v17, v17, v23
  v_dot2_f32_bf16 v20, v10, v2, v20
  v_dot2_f32_bf16 v21, v10, v10, v21
  v_dot2_f32_bf16 v22, v18, v2, v22
  v_dot2_f32_bf16 v23, v18, v18, v23
  v_dot2_f32_bf16 v20, v11, v2, v20
  v_dot2_f32_bf16 v21, v11, v11, v21
  v_dot2_f32_bf16 v22, v19, v2, v22
  v_dot2_f32_bf16 v23, v19, v19, v23
  v_add_f32_dpp v20, v20, v20 row_shr:1 row_mask:0xf bank_mask:0xf bound_ctrl:0
  v_add_f32_dpp v21, v21, v21 row_shr:1 row_mask:0xf bank_mask:0xf bound_ctrl:0
  v_add_f32_dpp v22, v22, v22 row_shr:1 row_mask:0xf bank_mask:0xf bound_ctrl:0
  v_add_f32_dpp v23, v23, v23 row_shr:1 row_mask:0xf bank_mask:0xf bound_ctrl:0
  v_add_f32_dpp v20, v20, v20 row_shr:2 row_mask:0xf bank_mask:0xf bound_ctrl:0
  v_add_f32_dpp v21, v21, v21 row_shr:2 row_mask:0xf bank_mask:0xf bound_ctrl:0
  v_add_f32_dpp v22, v22, v22 row_shr:2 row_mask:0xf bank_mask:0xf bound_ctrl:0
  v_add_f32_dpp v23, v23, v23 row_shr:2 row_mask:0xf bank_mask:0xf bound_ctrl:0
  v_add_f32_dpp v20, v20, v20 row_shr:4 row_mask:0xf bank_mask:0xf bound_ctrl:0
  v_add_f32_dpp v21, v21, v21 row_shr:4 row_mask:0xf bank_mask:0xf bound_ctrl:0
  v_add_f32_dpp v22, v22, v22 row_shr:4 row_mask:0xf bank_mask:0xf bound_ctrl:0
  v_add_f32_dpp v23, v23, v23 row_shr:4 row_mask:0xf bank_mask:0xf bound_ctrl:0
  v_add_f32_dpp v20, v20, v20 row_shr:8 row_mask:0xf bank_mask:0xf bound_ctrl:0
  v_add_f32_dpp v21, v21, v21 row_shr:8 row_mask:0xf bank_mask:0xf bound_ctrl:0
  v_add_f32_dpp v22, v22, v22 row_shr:8 row_mask:0xf bank_mask:0xf bound_ctrl:0
  v_add_f32_dpp v23, v23, v23 row_shr:8 row_mask:0xf bank_mask:0xf bound_ctrl:0
  v_add_f32_dpp v20, v20, v20 row_bcast:15 row_mask:0xa bank_mask:0xf
  v_add_f32_dpp v21, v21, v21 row_bcast:15 row_mask:0xa bank_mask:0xf
  v_add_f32_dpp v22, v22, v22 row_bcast:15 row_mask:0xa bank_mask:0xf
  v_add_f32_dpp v23, v23, v23 row_bcast:15 row_mask:0xa bank_mask:0xf
  s_mov_b32 s8, 0x3b124925
  v_pk_mul_f32 v[20:21], v[20:21], s[8:9] op_sel_hi:[1,0]
  v_pk_mul_f32 v[22:23], v[22:23], s[8:9] op_sel_hi:[1,0]
  s_mov_b32 s8, 0x3727c5ac
  v_fma_f32 v21, -v20, v20, v21
  v_fma_f32 v23, -v22, v22, v23
  v_max_f32 v21, 0, v21
  v_max_f32 v23, 0, v23
  v_cvt_pk_bf16_f32 v4, v21, v23
  v_lshrrev_b32 v2, 5, v1
  v_lshlrev_b32 v21, 16, v4
  v_and_b32 v23, 0xffff0000, v4
  v_add_f32 v21, s8, v21
  v_add_f32 v23, s8, v23
  v_cvt_pk_bf16_f32 v4, v21, v23
  s_lshl_b32 s8, s2, 4
  s_lshl_b32 s9, s5, 14
  s_add_u32 s8, s8, s9
  v_lshlrev_b32 v21, 16, v4
  v_and_b32 v23, 0xffff0000, v4
  v_sqrt_f32 v21, v21
  v_sqrt_f32 v23, v23
  s_add_u32 s8, s8, 2162688
  v_cvt_pk_bf16_f32 v8, v20, v22
  v_cvt_pk_bf16_f32 v4, v21, v23
  v_lshl_add_u32 v2, v2, 13, s8
  v_add_u32 v3, 4096, v2
  v_and_b32 v5, 0xffff0000, v4
  v_lshlrev_b32 v4, 16, v4
  v_rcp_f32 v5, v5
  v_rcp_f32 v4, v4
  v_and_b32 v9, 0xffff0000, v8
  v_lshlrev_b32 v8, 16, v8
  v_mov_b32 v6, s50
  v_mov_b32 v7, s50
  v_mov_b32 v10, s50
  v_mov_b32 v11, s50
  v_pk_mul_f32 v[8:9], v[8:9], v[4:5] neg_lo:[1,0] neg_hi:[1,0]
  s_mov_b32 exec_lo, 0x80000000
  s_mov_b32 exec_hi, 0x80000000
  global_store_dwordx4 v2, v[4:7], s[48:49] sc1
  global_store_dwordx4 v3, v[8:11], s[48:49] sc1
  s_mov_b64 exec, -1
  s_nop 0
  v_pk_fma_f32 v[162:163], v[162:163], v[152:153], v[170:171] op_sel:[1,1,0] op_sel_hi:[0,1,1] neg_lo:[1,0,0]
  v_cvt_pk_bf16_f32 v176, v78, -v79
  v_cvt_pk_bf16_f32 v177, v106, -v107
  v_cvt_pk_bf16_f32 v178, v134, -v135
  v_cvt_pk_bf16_f32 v179, v162, -v163
  ds_write_b128 v51, v[176:179] offset:39520
  v_pk_mul_f32 v[86:87], v[78:79], v[68:69] op_sel:[0,0] op_sel_hi:[1,0]
  v_pk_mul_f32 v[114:115], v[106:107], v[96:97] op_sel:[0,0] op_sel_hi:[1,0]
  v_pk_mul_f32 v[142:143], v[134:135], v[124:125] op_sel:[0,0] op_sel_hi:[1,0]
  v_pk_mul_f32 v[170:171], v[162:163], v[152:153] op_sel:[0,0] op_sel_hi:[1,0]
  v_pk_fma_f32 v[78:79], v[78:79], v[68:69], v[86:87] op_sel:[1,1,0] op_sel_hi:[0,1,1] neg_lo:[1,0,0]
  v_pk_fma_f32 v[106:107], v[106:107], v[96:97], v[114:115] op_sel:[1,1,0] op_sel_hi:[0,1,1] neg_lo:[1,0,0]
  v_pk_fma_f32 v[134:135], v[134:135], v[124:125], v[142:143] op_sel:[1,1,0] op_sel_hi:[0,1,1] neg_lo:[1,0,0]
  v_pk_fma_f32 v[162:163], v[162:163], v[152:153], v[170:171] op_sel:[1,1,0] op_sel_hi:[0,1,1] neg_lo:[1,0,0]
  v_cvt_pk_bf16_f32 v180, v78, -v79
  v_cvt_pk_bf16_f32 v181, v106, -v107
  v_cvt_pk_bf16_f32 v182, v134, -v135
  v_cvt_pk_bf16_f32 v183, v162, -v163
  ds_write_b128 v51, v[180:183] offset:40560
  s_mov_b32 s6, 0x43800000
  v_pk_mul_f32 v[84:85], v[64:65], s[6:7] op_sel_hi:[1,0]
  v_pk_mul_f32 v[112:113], v[92:93], s[6:7] op_sel_hi:[1,0]
  v_pk_mul_f32 v[140:141], v[120:121], s[6:7] op_sel_hi:[1,0]
  v_pk_mul_f32 v[168:169], v[148:149], s[6:7] op_sel_hi:[1,0]
  v_fract_f32 v85, v85
  v_exp_f32 v84, v84
  v_fract_f32 v113, v113
  v_exp_f32 v112, v112
  v_fract_f32 v141, v141
  v_exp_f32 v140, v140
  v_fract_f32 v169, v169
  v_exp_f32 v168, v168
  v_cos_f32 v74, v85
  v_sin_f32 v75, v85
  v_cos_f32 v102, v113
  v_sin_f32 v103, v113
  v_cos_f32 v130, v141
  v_sin_f32 v131, v141
  v_cos_f32 v158, v169
  v_sin_f32 v159, v169
  v_pk_mul_f32 v[74:75], v[74:75], v[84:85] op_sel:[0,0] op_sel_hi:[1,0]
  v_pk_mul_f32 v[102:103], v[102:103], v[112:113] op_sel:[0,0] op_sel_hi:[1,0]
  v_pk_mul_f32 v[130:131], v[130:131], v[140:141] op_sel:[0,0] op_sel_hi:[1,0]
  v_pk_mul_f32 v[158:159], v[158:159], v[168:169] op_sel:[0,0] op_sel_hi:[1,0]
  v_pk_mul_f32 v[86:87], v[68:69], v[68:69] op_sel:[0,0] op_sel_hi:[1,0]
  v_pk_mul_f32 v[114:115], v[96:97], v[96:97] op_sel:[0,0] op_sel_hi:[1,0]
  v_pk_mul_f32 v[142:143], v[124:125], v[124:125] op_sel:[0,0] op_sel_hi:[1,0]
  v_pk_mul_f32 v[170:171], v[152:153], v[152:153] op_sel:[0,0] op_sel_hi:[1,0]
  v_pk_fma_f32 v[70:71], v[68:69], v[68:69], v[86:87] op_sel:[1,1,0] op_sel_hi:[0,1,1] neg_lo:[1,0,0]
  v_pk_fma_f32 v[98:99], v[96:97], v[96:97], v[114:115] op_sel:[1,1,0] op_sel_hi:[0,1,1] neg_lo:[1,0,0]
  v_pk_fma_f32 v[126:127], v[124:125], v[124:125], v[142:143] op_sel:[1,1,0] op_sel_hi:[0,1,1] neg_lo:[1,0,0]
  v_pk_fma_f32 v[154:155], v[152:153], v[152:153], v[170:171] op_sel:[1,1,0] op_sel_hi:[0,1,1] neg_lo:[1,0,0]
  v_pk_mul_f32 v[86:87], v[70:71], v[70:71] op_sel:[0,0] op_sel_hi:[1,0]
  v_pk_mul_f32 v[114:115], v[98:99], v[98:99] op_sel:[0,0] op_sel_hi:[1,0]
  v_pk_mul_f32 v[142:143], v[126:127], v[126:127] op_sel:[0,0] op_sel_hi:[1,0]
  v_pk_mul_f32 v[170:171], v[154:155], v[154:155] op_sel:[0,0] op_sel_hi:[1,0]
  v_pk_fma_f32 v[72:73], v[70:71], v[70:71], v[86:87] op_sel:[1,1,0] op_sel_hi:[0,1,1] neg_lo:[1,0,0]
  v_pk_fma_f32 v[100:101], v[98:99], v[98:99], v[114:115] op_sel:[1,1,0] op_sel_hi:[0,1,1] neg_lo:[1,0,0]
  v_pk_fma_f32 v[128:129], v[126:127], v[126:127], v[142:143] op_sel:[1,1,0] op_sel_hi:[0,1,1] neg_lo:[1,0,0]
  v_pk_fma_f32 v[156:157], v[154:155], v[154:155], v[170:171] op_sel:[1,1,0] op_sel_hi:[0,1,1] neg_lo:[1,0,0]
  v_pk_mul_f32 v[86:87], v[66:67], v[74:75] op_sel:[0,0] op_sel_hi:[1,0]
  v_pk_mul_f32 v[114:115], v[94:95], v[102:103] op_sel:[0,0] op_sel_hi:[1,0]
  v_pk_mul_f32 v[142:143], v[122:123], v[130:131] op_sel:[0,0] op_sel_hi:[1,0]
  v_pk_mul_f32 v[170:171], v[150:151], v[158:159] op_sel:[0,0] op_sel_hi:[1,0]
  v_pk_fma_f32 v[80:81], v[66:67], v[74:75], v[86:87] op_sel:[1,1,0] op_sel_hi:[0,1,1] neg_lo:[1,0,0]
  v_pk_fma_f32 v[108:109], v[94:95], v[102:103], v[114:115] op_sel:[1,1,0] op_sel_hi:[0,1,1] neg_lo:[1,0,0]
  v_pk_fma_f32 v[136:137], v[122:123], v[130:131], v[142:143] op_sel:[1,1,0] op_sel_hi:[0,1,1] neg_lo:[1,0,0]
  v_pk_fma_f32 v[164:165], v[150:151], v[158:159], v[170:171] op_sel:[1,1,0] op_sel_hi:[0,1,1] neg_lo:[1,0,0]
  v_cvt_pk_bf16_f32 v176, v80, -v81
  v_cvt_pk_bf16_f32 v177, v108, -v109
  v_cvt_pk_bf16_f32 v178, v136, -v137
  v_cvt_pk_bf16_f32 v179, v164, -v165
  ds_write_b128 v51, v[176:179] offset:41600
  v_pk_mul_f32 v[86:87], v[80:81], v[70:71] op_sel:[0,0] op_sel_hi:[1,0]
  v_pk_mul_f32 v[114:115], v[108:109], v[98:99] op_sel:[0,0] op_sel_hi:[1,0]
  v_pk_mul_f32 v[142:143], v[136:137], v[126:127] op_sel:[0,0] op_sel_hi:[1,0]
  v_pk_mul_f32 v[170:171], v[164:165], v[154:155] op_sel:[0,0] op_sel_hi:[1,0]
  v_pk_fma_f32 v[78:79], v[80:81], v[70:71], v[86:87] op_sel:[1,1,0] op_sel_hi:[0,1,1] neg_lo:[1,0,0]
  v_pk_fma_f32 v[106:107], v[108:109], v[98:99], v[114:115] op_sel:[1,1,0] op_sel_hi:[0,1,1] neg_lo:[1,0,0]
  v_pk_fma_f32 v[134:135], v[136:137], v[126:127], v[142:143] op_sel:[1,1,0] op_sel_hi:[0,1,1] neg_lo:[1,0,0]
  v_pk_fma_f32 v[162:163], v[164:165], v[154:155], v[170:171] op_sel:[1,1,0] op_sel_hi:[0,1,1] neg_lo:[1,0,0]
  v_cvt_pk_bf16_f32 v180, v78, -v79
  v_cvt_pk_bf16_f32 v181, v106, -v107
  v_cvt_pk_bf16_f32 v182, v134, -v135
  v_cvt_pk_bf16_f32 v183, v162, -v163
  ds_write_b128 v51, v[180:183] offset:42640
  v_pk_mul_f32 v[86:87], v[78:79], v[70:71] op_sel:[0,0] op_sel_hi:[1,0]
  v_pk_mul_f32 v[114:115], v[106:107], v[98:99] op_sel:[0,0] op_sel_hi:[1,0]
  v_pk_mul_f32 v[142:143], v[134:135], v[126:127] op_sel:[0,0] op_sel_hi:[1,0]
  v_pk_mul_f32 v[170:171], v[162:163], v[154:155] op_sel:[0,0] op_sel_hi:[1,0]
  v_pk_fma_f32 v[78:79], v[78:79], v[70:71], v[86:87] op_sel:[1,1,0] op_sel_hi:[0,1,1] neg_lo:[1,0,0]
  v_pk_fma_f32 v[106:107], v[106:107], v[98:99], v[114:115] op_sel:[1,1,0] op_sel_hi:[0,1,1] neg_lo:[1,0,0]
  v_pk_fma_f32 v[134:135], v[134:135], v[126:127], v[142:143] op_sel:[1,1,0] op_sel_hi:[0,1,1] neg_lo:[1,0,0]
  v_pk_fma_f32 v[162:163], v[162:163], v[154:155], v[170:171] op_sel:[1,1,0] op_sel_hi:[0,1,1] neg_lo:[1,0,0]
  v_cvt_pk_bf16_f32 v176, v78, -v79
  v_cvt_pk_bf16_f32 v177, v106, -v107
  v_cvt_pk_bf16_f32 v178, v134, -v135
  v_cvt_pk_bf16_f32 v179, v162, -v163
  ds_write_b128 v51, v[176:179] offset:43680
  v_pk_mul_f32 v[86:87], v[78:79], v[70:71] op_sel:[0,0] op_sel_hi:[1,0]
  v_pk_mul_f32 v[114:115], v[106:107], v[98:99] op_sel:[0,0] op_sel_hi:[1,0]
  v_pk_mul_f32 v[142:143], v[134:135], v[126:127] op_sel:[0,0] op_sel_hi:[1,0]
  v_pk_mul_f32 v[170:171], v[162:163], v[154:155] op_sel:[0,0] op_sel_hi:[1,0]
  v_pk_fma_f32 v[78:79], v[78:79], v[70:71], v[86:87] op_sel:[1,1,0] op_sel_hi:[0,1,1] neg_lo:[1,0,0]
  v_pk_fma_f32 v[106:107], v[106:107], v[98:99], v[114:115] op_sel:[1,1,0] op_sel_hi:[0,1,1] neg_lo:[1,0,0]
  v_pk_fma_f32 v[134:135], v[134:135], v[126:127], v[142:143] op_sel:[1,1,0] op_sel_hi:[0,1,1] neg_lo:[1,0,0]
  v_pk_fma_f32 v[162:163], v[162:163], v[154:155], v[170:171] op_sel:[1,1,0] op_sel_hi:[0,1,1] neg_lo:[1,0,0]
  v_cvt_pk_bf16_f32 v180, v78, -v79
  v_cvt_pk_bf16_f32 v181, v106, -v107
  v_cvt_pk_bf16_f32 v182, v134, -v135
  v_cvt_pk_bf16_f32 v183, v162, -v163
  ds_write_b128 v51, v[180:183] offset:44720
  v_pk_mul_f32 v[86:87], v[80:81], v[74:75] op_sel:[0,0] op_sel_hi:[1,0]
  v_pk_mul_f32 v[114:115], v[108:109], v[102:103] op_sel:[0,0] op_sel_hi:[1,0]
  v_pk_mul_f32 v[142:143], v[136:137], v[130:131] op_sel:[0,0] op_sel_hi:[1,0]
  v_pk_mul_f32 v[170:171], v[164:165], v[158:159] op_sel:[0,0] op_sel_hi:[1,0]
  v_pk_fma_f32 v[82:83], v[80:81], v[74:75], v[86:87] op_sel:[1,1,0] op_sel_hi:[0,1,1] neg_lo:[1,0,0]
  v_pk_fma_f32 v[110:111], v[108:109], v[102:103], v[114:115] op_sel:[1,1,0] op_sel_hi:[0,1,1] neg_lo:[1,0,0]
  v_pk_fma_f32 v[138:139], v[136:137], v[130:131], v[142:143] op_sel:[1,1,0] op_sel_hi:[0,1,1] neg_lo:[1,0,0]
  v_pk_fma_f32 v[166:167], v[164:165], v[158:159], v[170:171] op_sel:[1,1,0] op_sel_hi:[0,1,1] neg_lo:[1,0,0]
  v_cvt_pk_bf16_f32 v176, v82, -v83
  v_cvt_pk_bf16_f32 v177, v110, -v111
  v_cvt_pk_bf16_f32 v178, v138, -v139
  v_cvt_pk_bf16_f32 v179, v166, -v167
  ds_write_b128 v51, v[176:179] offset:45760
  v_pk_mul_f32 v[86:87], v[82:83], v[72:73] op_sel:[0,0] op_sel_hi:[1,0]
  v_pk_mul_f32 v[114:115], v[110:111], v[100:101] op_sel:[0,0] op_sel_hi:[1,0]
  v_pk_mul_f32 v[142:143], v[138:139], v[128:129] op_sel:[0,0] op_sel_hi:[1,0]
  v_pk_mul_f32 v[170:171], v[166:167], v[156:157] op_sel:[0,0] op_sel_hi:[1,0]
  v_pk_fma_f32 v[78:79], v[82:83], v[72:73], v[86:87] op_sel:[1,1,0] op_sel_hi:[0,1,1] neg_lo:[1,0,0]
  v_pk_fma_f32 v[106:107], v[110:111], v[100:101], v[114:115] op_sel:[1,1,0] op_sel_hi:[0,1,1] neg_lo:[1,0,0]
  v_pk_fma_f32 v[134:135], v[138:139], v[128:129], v[142:143] op_sel:[1,1,0] op_sel_hi:[0,1,1] neg_lo:[1,0,0]
  v_pk_fma_f32 v[162:163], v[166:167], v[156:157], v[170:171] op_sel:[1,1,0] op_sel_hi:[0,1,1] neg_lo:[1,0,0]
  v_cvt_pk_bf16_f32 v180, v78, -v79
  v_cvt_pk_bf16_f32 v181, v106, -v107
  v_cvt_pk_bf16_f32 v182, v134, -v135
  v_cvt_pk_bf16_f32 v183, v162, -v163
  ds_write_b128 v51, v[180:183] offset:46800
  v_pk_mul_f32 v[86:87], v[82:83], v[74:75] op_sel:[0,0] op_sel_hi:[1,0]
  v_pk_mul_f32 v[114:115], v[110:111], v[102:103] op_sel:[0,0] op_sel_hi:[1,0]
  v_pk_mul_f32 v[142:143], v[138:139], v[130:131] op_sel:[0,0] op_sel_hi:[1,0]
  v_pk_mul_f32 v[170:171], v[166:167], v[158:159] op_sel:[0,0] op_sel_hi:[1,0]
  v_pk_fma_f32 v[82:83], v[82:83], v[74:75], v[86:87] op_sel:[1,1,0] op_sel_hi:[0,1,1] neg_lo:[1,0,0]
  v_pk_fma_f32 v[110:111], v[110:111], v[102:103], v[114:115] op_sel:[1,1,0] op_sel_hi:[0,1,1] neg_lo:[1,0,0]
  v_pk_fma_f32 v[138:139], v[138:139], v[130:131], v[142:143] op_sel:[1,1,0] op_sel_hi:[0,1,1] neg_lo:[1,0,0]
  v_pk_fma_f32 v[166:167], v[166:167], v[158:159], v[170:171] op_sel:[1,1,0] op_sel_hi:[0,1,1] neg_lo:[1,0,0]
  v_cvt_pk_bf16_f32 v176, v82, -v83
  v_cvt_pk_bf16_f32 v177, v110, -v111
  v_cvt_pk_bf16_f32 v178, v138, -v139
  v_cvt_pk_bf16_f32 v179, v166, -v167
  ds_write_b128 v51, v[176:179] offset:47840
  v_pk_mul_f32 v[86:87], v[82:83], v[72:73] op_sel:[0,0] op_sel_hi:[1,0]
  v_pk_mul_f32 v[114:115], v[110:111], v[100:101] op_sel:[0,0] op_sel_hi:[1,0]
  v_pk_mul_f32 v[142:143], v[138:139], v[128:129] op_sel:[0,0] op_sel_hi:[1,0]
  v_pk_mul_f32 v[170:171], v[166:167], v[156:157] op_sel:[0,0] op_sel_hi:[1,0]
  v_pk_fma_f32 v[78:79], v[82:83], v[72:73], v[86:87] op_sel:[1,1,0] op_sel_hi:[0,1,1] neg_lo:[1,0,0]
  v_pk_fma_f32 v[106:107], v[110:111], v[100:101], v[114:115] op_sel:[1,1,0] op_sel_hi:[0,1,1] neg_lo:[1,0,0]
  v_pk_fma_f32 v[134:135], v[138:139], v[128:129], v[142:143] op_sel:[1,1,0] op_sel_hi:[0,1,1] neg_lo:[1,0,0]
  v_pk_fma_f32 v[162:163], v[166:167], v[156:157], v[170:171] op_sel:[1,1,0] op_sel_hi:[0,1,1] neg_lo:[1,0,0]
  v_cvt_pk_bf16_f32 v180, v78, -v79
  v_cvt_pk_bf16_f32 v181, v106, -v107
  v_cvt_pk_bf16_f32 v182, v134, -v135
  v_cvt_pk_bf16_f32 v183, v162, -v163
  ds_write_b128 v51, v[180:183] offset:48880
  v_pk_mul_f32 v[86:87], v[82:83], v[74:75] op_sel:[0,0] op_sel_hi:[1,0]
  v_pk_mul_f32 v[114:115], v[110:111], v[102:103] op_sel:[0,0] op_sel_hi:[1,0]
  v_pk_mul_f32 v[142:143], v[138:139], v[130:131] op_sel:[0,0] op_sel_hi:[1,0]
  v_pk_mul_f32 v[170:171], v[166:167], v[158:159] op_sel:[0,0] op_sel_hi:[1,0]
  v_pk_fma_f32 v[80:81], v[82:83], v[74:75], v[86:87] op_sel:[1,1,0] op_sel_hi:[0,1,1] neg_lo:[1,0,0]
  v_pk_fma_f32 v[108:109], v[110:111], v[102:103], v[114:115] op_sel:[1,1,0] op_sel_hi:[0,1,1] neg_lo:[1,0,0]
  v_pk_fma_f32 v[136:137], v[138:139], v[130:131], v[142:143] op_sel:[1,1,0] op_sel_hi:[0,1,1] neg_lo:[1,0,0]
  v_pk_fma_f32 v[164:165], v[166:167], v[158:159], v[170:171] op_sel:[1,1,0] op_sel_hi:[0,1,1] neg_lo:[1,0,0]
  v_cvt_pk_bf16_f32 v176, v80, -v81
  v_cvt_pk_bf16_f32 v177, v108, -v109
  v_cvt_pk_bf16_f32 v178, v136, -v137
  v_cvt_pk_bf16_f32 v179, v164, -v165
  ds_write_b128 v51, v[176:179] offset:49920
  v_pk_mul_f32 v[86:87], v[80:81], v[74:75] op_sel:[0,0] op_sel_hi:[1,0]
  v_pk_mul_f32 v[114:115], v[108:109], v[102:103] op_sel:[0,0] op_sel_hi:[1,0]
  v_pk_mul_f32 v[142:143], v[136:137], v[130:131] op_sel:[0,0] op_sel_hi:[1,0]
  v_pk_mul_f32 v[170:171], v[164:165], v[158:159] op_sel:[0,0] op_sel_hi:[1,0]
  v_pk_fma_f32 v[78:79], v[80:81], v[74:75], v[86:87] op_sel:[1,1,0] op_sel_hi:[0,1,1] neg_lo:[1,0,0]
  v_pk_fma_f32 v[106:107], v[108:109], v[102:103], v[114:115] op_sel:[1,1,0] op_sel_hi:[0,1,1] neg_lo:[1,0,0]
  v_pk_fma_f32 v[134:135], v[136:137], v[130:131], v[142:143] op_sel:[1,1,0] op_sel_hi:[0,1,1] neg_lo:[1,0,0]
  v_pk_fma_f32 v[162:163], v[164:165], v[158:159], v[170:171] op_sel:[1,1,0] op_sel_hi:[0,1,1] neg_lo:[1,0,0]
  v_cvt_pk_bf16_f32 v180, v78, -v79
  v_cvt_pk_bf16_f32 v181, v106, -v107
  v_cvt_pk_bf16_f32 v182, v134, -v135
  v_cvt_pk_bf16_f32 v183, v162, -v163
  ds_write_b128 v51, v[180:183] offset:50960
  v_pk_mul_f32 v[86:87], v[78:79], v[74:75] op_sel:[0,0] op_sel_hi:[1,0]
  v_pk_mul_f32 v[114:115], v[106:107], v[102:103] op_sel:[0,0] op_sel_hi:[1,0]
  v_pk_mul_f32 v[142:143], v[134:135], v[130:131] op_sel:[0,0] op_sel_hi:[1,0]
  v_pk_mul_f32 v[170:171], v[162:163], v[158:159] op_sel:[0,0] op_sel_hi:[1,0]
  v_pk_fma_f32 v[78:79], v[78:79], v[74:75], v[86:87] op_sel:[1,1,0] op_sel_hi:[0,1,1] neg_lo:[1,0,0]
  v_pk_fma_f32 v[106:107], v[106:107], v[102:103], v[114:115] op_sel:[1,1,0] op_sel_hi:[0,1,1] neg_lo:[1,0,0]
  v_pk_fma_f32 v[134:135], v[134:135], v[130:131], v[142:143] op_sel:[1,1,0] op_sel_hi:[0,1,1] neg_lo:[1,0,0]
  v_pk_fma_f32 v[162:163], v[162:163], v[158:159], v[170:171] op_sel:[1,1,0] op_sel_hi:[0,1,1] neg_lo:[1,0,0]
  v_cvt_pk_bf16_f32 v176, v78, -v79
  v_cvt_pk_bf16_f32 v177, v106, -v107
  v_cvt_pk_bf16_f32 v178, v134, -v135
  v_cvt_pk_bf16_f32 v179, v162, -v163
  ds_write_b128 v51, v[176:179] offset:52000
  v_pk_mul_f32 v[86:87], v[78:79], v[74:75] op_sel:[0,0] op_sel_hi:[1,0]
  v_pk_mul_f32 v[114:115], v[106:107], v[102:103] op_sel:[0,0] op_sel_hi:[1,0]
  v_pk_mul_f32 v[142:143], v[134:135], v[130:131] op_sel:[0,0] op_sel_hi:[1,0]
  v_pk_mul_f32 v[170:171], v[162:163], v[158:159] op_sel:[0,0] op_sel_hi:[1,0]
  v_pk_fma_f32 v[78:79], v[78:79], v[74:75], v[86:87] op_sel:[1,1,0] op_sel_hi:[0,1,1] neg_lo:[1,0,0]
  v_pk_fma_f32 v[106:107], v[106:107], v[102:103], v[114:115] op_sel:[1,1,0] op_sel_hi:[0,1,1] neg_lo:[1,0,0]
  v_pk_fma_f32 v[134:135], v[134:135], v[130:131], v[142:143] op_sel:[1,1,0] op_sel_hi:[0,1,1] neg_lo:[1,0,0]
  v_pk_fma_f32 v[162:163], v[162:163], v[158:159], v[170:171] op_sel:[1,1,0] op_sel_hi:[0,1,1] neg_lo:[1,0,0]
  v_cvt_pk_bf16_f32 v180, v78, -v79
  v_cvt_pk_bf16_f32 v181, v106, -v107
  v_cvt_pk_bf16_f32 v182, v134, -v135
  v_cvt_pk_bf16_f32 v183, v162, -v163
  ds_write_b128 v51, v[180:183] offset:53040
  v_pk_mul_f32 v[86:87], v[78:79], v[74:75] op_sel:[0,0] op_sel_hi:[1,0]
  v_pk_mul_f32 v[114:115], v[106:107], v[102:103] op_sel:[0,0] op_sel_hi:[1,0]
  v_pk_mul_f32 v[142:143], v[134:135], v[130:131] op_sel:[0,0] op_sel_hi:[1,0]
  v_pk_mul_f32 v[170:171], v[162:163], v[158:159] op_sel:[0,0] op_sel_hi:[1,0]
  v_pk_fma_f32 v[78:79], v[78:79], v[74:75], v[86:87] op_sel:[1,1,0] op_sel_hi:[0,1,1] neg_lo:[1,0,0]
  v_pk_fma_f32 v[106:107], v[106:107], v[102:103], v[114:115] op_sel:[1,1,0] op_sel_hi:[0,1,1] neg_lo:[1,0,0]
  v_pk_fma_f32 v[134:135], v[134:135], v[130:131], v[142:143] op_sel:[1,1,0] op_sel_hi:[0,1,1] neg_lo:[1,0,0]
  v_pk_fma_f32 v[162:163], v[162:163], v[158:159], v[170:171] op_sel:[1,1,0] op_sel_hi:[0,1,1] neg_lo:[1,0,0]
  v_cvt_pk_bf16_f32 v176, v78, -v79
  v_cvt_pk_bf16_f32 v177, v106, -v107
  v_cvt_pk_bf16_f32 v178, v134, -v135
  v_cvt_pk_bf16_f32 v179, v162, -v163
  ds_write_b128 v51, v[176:179] offset:54080
  s_branch L_kdone
L_pwave:
  s_lshl_b32 s6, s5, 4
  s_waitcnt lgkmcnt(0)
  s_lshr_b32 s6, s58, s6
  s_lshl_b32 s6, s6, 16
  v_mov_b32 v2, s6
  v_mul_f32 v2, 0x3fb8aa3b, v2
  v_exp_f32 v2, v2
  s_waitcnt vmcnt(3)
  v_lshlrev_b32 v64, 16, v208
  s_waitcnt vmcnt(2)
  v_lshlrev_b32_e64 v65, 16, v210
  v_cvt_pk_bf16_f32 v2, v2, v2
  v_and_b32 v2, 0xffff0000, v2
  v_and_b32 v92, 0xffff0000, v208
  v_and_b32 v93, 0xffff0000, v210
  v_lshlrev_b32 v120, 16, v209
  v_lshlrev_b32 v121, 16, v211
  v_and_b32 v148, 0xffff0000, v209
  v_and_b32 v149, 0xffff0000, v211
  v_pk_mul_f32 v[64:65], v[64:65], v[2:3] op_sel_hi:[1,0]
  v_pk_mul_f32 v[92:93], v[92:93], v[2:3] op_sel_hi:[1,0]
  v_pk_mul_f32 v[120:121], v[120:121], v[2:3] op_sel_hi:[1,0]
  v_pk_mul_f32 v[148:149], v[148:149], v[2:3] op_sel_hi:[1,0]
  s_mov_b32 s6, 0x3fb8aa3b
  s_mov_b32 s7, 0x3e22f983
  s_nop 0
  v_pk_mul_f32 v[64:65], v[64:65], s[6:7]
  v_pk_mul_f32 v[92:93], v[92:93], s[6:7]
  v_pk_mul_f32 v[120:121], v[120:121], s[6:7]
  v_pk_mul_f32 v[148:149], v[148:149], s[6:7]
  s_mov_b32 s6, 0x41000000
  v_pk_mul_f32 v[84:85], v[64:65], s[6:7] op_sel_hi:[1,0]
  v_pk_mul_f32 v[112:113], v[92:93], s[6:7] op_sel_hi:[1,0]
  v_pk_mul_f32 v[140:141], v[120:121], s[6:7] op_sel_hi:[1,0]
  v_pk_mul_f32 v[168:169], v[148:149], s[6:7] op_sel_hi:[1,0]
  v_fract_f32 v85, v85
  v_exp_f32 v84, v84
  v_fract_f32 v113, v113
  v_exp_f32 v112, v112
  v_fract_f32 v141, v141
  v_exp_f32 v140, v140
  v_fract_f32 v169, v169
  v_exp_f32 v168, v168
  v_cos_f32 v68, v85
  v_sin_f32 v69, v85
  v_cos_f32 v96, v113
  v_sin_f32 v97, v113
  v_cos_f32 v124, v141
  v_sin_f32 v125, v141
  v_cos_f32 v152, v169
  v_sin_f32 v153, v169
  v_pk_mul_f32 v[68:69], v[68:69], v[84:85] op_sel:[0,0] op_sel_hi:[1,0]
  v_pk_mul_f32 v[96:97], v[96:97], v[112:113] op_sel:[0,0] op_sel_hi:[1,0]
  v_pk_mul_f32 v[124:125], v[124:125], v[140:141] op_sel:[0,0] op_sel_hi:[1,0]
  v_pk_mul_f32 v[152:153], v[152:153], v[168:169] op_sel:[0,0] op_sel_hi:[1,0]
  v_cvt_pk_bf16_f32 v180, v68, v69
  v_cvt_pk_bf16_f32 v181, v96, v97
  v_cvt_pk_bf16_f32 v182, v124, v125
  v_cvt_pk_bf16_f32 v183, v152, v153
  ds_write_b128 v51, v[180:183] offset:1040
  v_pk_mul_f32 v[86:87], v[68:69], v[68:69] op_sel:[0,0] op_sel_hi:[1,0]
  v_pk_mul_f32 v[114:115], v[96:97], v[96:97] op_sel:[0,0] op_sel_hi:[1,0]
  v_pk_mul_f32 v[142:143], v[124:125], v[124:125] op_sel:[0,0] op_sel_hi:[1,0]
  v_pk_mul_f32 v[170:171], v[152:153], v[152:153] op_sel:[0,0] op_sel_hi:[1,0]
  v_pk_fma_f32 v[70:71], v[68:69], v[68:69], v[86:87] op_sel:[1,1,0] op_sel_hi:[0,1,1] neg_lo:[1,0,0]
  v_pk_fma_f32 v[98:99], v[96:97], v[96:97], v[114:115] op_sel:[1,1,0] op_sel_hi:[0,1,1] neg_lo:[1,0,0]
  v_pk_fma_f32 v[126:127], v[124:125], v[124:125], v[142:143] op_sel:[1,1,0] op_sel_hi:[0,1,1] neg_lo:[1,0,0]
  v_pk_fma_f32 v[154:155], v[152:153], v[152:153], v[170:171] op_sel:[1,1,0] op_sel_hi:[0,1,1] neg_lo:[1,0,0]
  v_cvt_pk_bf16_f32 v176, v70, v71
  v_cvt_pk_bf16_f32 v177, v98, v99
  v_cvt_pk_bf16_f32 v178, v126, v127
  v_cvt_pk_bf16_f32 v179, v154, v155
  ds_write_b128 v51, v[176:179] offset:2080
  v_pk_mul_f32 v[86:87], v[70:71], v[68:69] op_sel:[0,0] op_sel_hi:[1,0]
  v_pk_mul_f32 v[114:115], v[98:99], v[96:97] op_sel:[0,0] op_sel_hi:[1,0]
  v_pk_mul_f32 v[142:143], v[126:127], v[124:125] op_sel:[0,0] op_sel_hi:[1,0]
  v_pk_mul_f32 v[170:171], v[154:155], v[152:153] op_sel:[0,0] op_sel_hi:[1,0]
  v_pk_fma_f32 v[70:71], v[70:71], v[68:69], v[86:87] op_sel:[1,1,0] op_sel_hi:[0,1,1] neg_lo:[1,0,0]
  v_pk_fma_f32 v[98:99], v[98:99], v[96:97], v[114:115] op_sel:[1,1,0] op_sel_hi:[0,1,1] neg_lo:[1,0,0]
  v_pk_fma_f32 v[126:127], v[126:127], v[124:125], v[142:143] op_sel:[1,1,0] op_sel_hi:[0,1,1] neg_lo:[1,0,0]
  v_pk_fma_f32 v[154:155], v[154:155], v[152:153], v[170:171] op_sel:[1,1,0] op_sel_hi:[0,1,1] neg_lo:[1,0,0]
  v_cvt_pk_bf16_f32 v180, v70, v71
  v_cvt_pk_bf16_f32 v181, v98, v99
  v_cvt_pk_bf16_f32 v182, v126, v127
  v_cvt_pk_bf16_f32 v183, v154, v155
  ds_write_b128 v51, v[180:183] offset:3120
  v_pk_mul_f32 v[86:87], v[70:71], v[68:69] op_sel:[0,0] op_sel_hi:[1,0]
  v_pk_mul_f32 v[114:115], v[98:99], v[96:97] op_sel:[0,0] op_sel_hi:[1,0]
  v_pk_mul_f32 v[142:143], v[126:127], v[124:125] op_sel:[0,0] op_sel_hi:[1,0]
  v_pk_mul_f32 v[170:171], v[154:155], v[152:153] op_sel:[0,0] op_sel_hi:[1,0]
  v_pk_fma_f32 v[70:71], v[70:71], v[68:69], v[86:87] op_sel:[1,1,0] op_sel_hi:[0,1,1] neg_lo:[1,0,0]
  v_pk_fma_f32 v[98:99], v[98:99], v[96:97], v[114:115] op_sel:[1,1,0] op_sel_hi:[0,1,1] neg_lo:[1,0,0]
  v_pk_fma_f32 v[126:127], v[126:127], v[124:125], v[142:143] op_sel:[1,1,0] op_sel_hi:[0,1,1] neg_lo:[1,0,0]
  v_pk_fma_f32 v[154:155], v[154:155], v[152:153], v[170:171] op_sel:[1,1,0] op_sel_hi:[0,1,1] neg_lo:[1,0,0]
  v_cvt_pk_bf16_f32 v176, v70, v71
  v_cvt_pk_bf16_f32 v177, v98, v99
  v_cvt_pk_bf16_f32 v178, v126, v127
  v_cvt_pk_bf16_f32 v179, v154, v155
  ds_write_b128 v51, v[176:179] offset:4160
  v_pk_mul_f32 v[86:87], v[70:71], v[68:69] op_sel:[0,0] op_sel_hi:[1,0]
  v_pk_mul_f32 v[114:115], v[98:99], v[96:97] op_sel:[0,0] op_sel_hi:[1,0]
  v_pk_mul_f32 v[142:143], v[126:127], v[124:125] op_sel:[0,0] op_sel_hi:[1,0]
  v_pk_mul_f32 v[170:171], v[154:155], v[152:153] op_sel:[0,0] op_sel_hi:[1,0]
  v_pk_fma_f32 v[70:71], v[70:71], v[68:69], v[86:87] op_sel:[1,1,0] op_sel_hi:[0,1,1] neg_lo:[1,0,0]
  v_pk_fma_f32 v[98:99], v[98:99], v[96:97], v[114:115] op_sel:[1,1,0] op_sel_hi:[0,1,1] neg_lo:[1,0,0]
  v_pk_fma_f32 v[126:127], v[126:127], v[124:125], v[142:143] op_sel:[1,1,0] op_sel_hi:[0,1,1] neg_lo:[1,0,0]
  v_pk_fma_f32 v[154:155], v[154:155], v[152:153], v[170:171] op_sel:[1,1,0] op_sel_hi:[0,1,1] neg_lo:[1,0,0]
  v_cvt_pk_bf16_f32 v180, v70, v71
  v_cvt_pk_bf16_f32 v181, v98, v99
  v_cvt_pk_bf16_f32 v182, v126, v127
  v_cvt_pk_bf16_f32 v183, v154, v155
  ds_write_b128 v51, v[180:183] offset:5200
  v_pk_mul_f32 v[86:87], v[70:71], v[68:69] op_sel:[0,0] op_sel_hi:[1,0]
  v_pk_mul_f32 v[114:115], v[98:99], v[96:97] op_sel:[0,0] op_sel_hi:[1,0]
  v_pk_mul_f32 v[142:143], v[126:127], v[124:125] op_sel:[0,0] op_sel_hi:[1,0]
  v_pk_mul_f32 v[170:171], v[154:155], v[152:153] op_sel:[0,0] op_sel_hi:[1,0]
  v_pk_fma_f32 v[70:71], v[70:71], v[68:69], v[86:87] op_sel:[1,1,0] op_sel_hi:[0,1,1] neg_lo:[1,0,0]
  v_pk_fma_f32 v[98:99], v[98:99], v[96:97], v[114:115] op_sel:[1,1,0] op_sel_hi:[0,1,1] neg_lo:[1,0,0]
  v_pk_fma_f32 v[126:127], v[126:127], v[124:125], v[142:143] op_sel:[1,1,0] op_sel_hi:[0,1,1] neg_lo:[1,0,0]
  v_pk_fma_f32 v[154:155], v[154:155], v[152:153], v[170:171] op_sel:[1,1,0] op_sel_hi:[0,1,1] neg_lo:[1,0,0]
  v_cvt_pk_bf16_f32 v176, v70, v71
  v_cvt_pk_bf16_f32 v177, v98, v99
  v_cvt_pk_bf16_f32 v178, v126, v127
  v_cvt_pk_bf16_f32 v179, v154, v155
  ds_write_b128 v51, v[176:179] offset:6240
  v_pk_mul_f32 v[86:87], v[70:71], v[68:69] op_sel:[0,0] op_sel_hi:[1,0]
  v_pk_mul_f32 v[114:115], v[98:99], v[96:97] op_sel:[0,0] op_sel_hi:[1,0]
  v_pk_mul_f32 v[142:143], v[126:127], v[124:125] op_sel:[0,0] op_sel_hi:[1,0]
  v_pk_mul_f32 v[170:171], v[154:155], v[152:153] op_sel:[0,0] op_sel_hi:[1,0]
  v_pk_fma_f32 v[70:71], v[70:71], v[68:69], v[86:87] op_sel:[1,1,0] op_sel_hi:[0,1,1] neg_lo:[1,0,0]
  v_pk_fma_f32 v[98:99], v[98:99], v[96:97], v[114:115] op_sel:[1,1,0] op_sel_hi:[0,1,1] neg_lo:[1,0,0]
  v_pk_fma_f32 v[126:127], v[126:127], v[124:125], v[142:143] op_sel:[1,1,0] op_sel_hi:[0,1,1] neg_lo:[1,0,0]
  v_pk_fma_f32 v[154:155], v[154:155], v[152:153], v[170:171] op_sel:[1,1,0] op_sel_hi:[0,1,1] neg_lo:[1,0,0]
  v_cvt_pk_bf16_f32 v180, v70, v71
  v_cvt_pk_bf16_f32 v181, v98, v99
  v_cvt_pk_bf16_f32 v182, v126, v127
  v_cvt_pk_bf16_f32 v183, v154, v155
  ds_write_b128 v51, v[180:183] offset:7280
  v_pk_mul_f32 v[86:87], v[70:71], v[68:69] op_sel:[0,0] op_sel_hi:[1,0]
  v_pk_mul_f32 v[114:115], v[98:99], v[96:97] op_sel:[0,0] op_sel_hi:[1,0]
  v_pk_mul_f32 v[142:143], v[126:127], v[124:125] op_sel:[0,0] op_sel_hi:[1,0]
  v_pk_mul_f32 v[170:171], v[154:155], v[152:153] op_sel:[0,0] op_sel_hi:[1,0]
  v_pk_fma_f32 v[70:71], v[70:71], v[68:69], v[86:87] op_sel:[1,1,0] op_sel_hi:[0,1,1] neg_lo:[1,0,0]
  v_pk_fma_f32 v[98:99], v[98:99], v[96:97], v[114:115] op_sel:[1,1,0] op_sel_hi:[0,1,1] neg_lo:[1,0,0]
  v_pk_fma_f32 v[126:127], v[126:127], v[124:125], v[142:143] op_sel:[1,1,0] op_sel_hi:[0,1,1] neg_lo:[1,0,0]
  v_pk_fma_f32 v[154:155], v[154:155], v[152:153], v[170:171] op_sel:[1,1,0] op_sel_hi:[0,1,1] neg_lo:[1,0,0]
  v_cvt_pk_bf16_f32 v176, v70, v71
  v_cvt_pk_bf16_f32 v177, v98, v99
  v_cvt_pk_bf16_f32 v178, v126, v127
  s_add_u32 s51, s51, 1
  s_mul_i32 s50, s51, 0x9E3779B1
  s_add_u32 s50, s50, 0x7F4A7C15
  s_waitcnt vmcnt(0)
  ds_read_b64_tr_b16 v[184:185], v36 offset:0
  ds_read_b64_tr_b16 v[188:189], v36 offset:16
  ds_read_b64_tr_b16 v[192:193], v36 offset:32
  ds_read_b64_tr_b16 v[196:197], v36 offset:48
  v_mov_b32 v187, s50
  v_mov_b32 v191, s50
  v_mov_b32 v195, s50
  v_mov_b32 v199, s50
  s_waitcnt lgkmcnt(3)
  v_mov_b32 v186, v185
  v_mov_b32 v185, s50
  global_store_dwordx4 v37, v[184:187], s[48:49] sc1
  v_add_u32 v37, 66560, v37
  s_waitcnt lgkmcnt(2)
  v_mov_b32 v190, v189
  v_mov_b32 v189, s50
  global_store_dwordx4 v37, v[188:191], s[48:49] sc1
  v_add_u32 v37, 66560, v37
  s_waitcnt lgkmcnt(1)
  v_mov_b32 v194, v193
  v_mov_b32 v193, s50
  global_store_dwordx4 v37, v[192:195], s[48:49] sc1
  v_add_u32 v37, 66560, v37
  s_waitcnt lgkmcnt(0)
  v_mov_b32 v198, v197
  v_mov_b32 v197, s50
  global_store_dwordx4 v37, v[196:199], s[48:49] sc1
  v_cvt_pk_bf16_f32 v179, v154, v155
  ds_write_b128 v51, v[176:179] offset:8320
  v_pk_mul_f32 v[86:87], v[70:71], v[68:69] op_sel:[0,0] op_sel_hi:[1,0]
  v_pk_mul_f32 v[114:115], v[98:99], v[96:97] op_sel:[0,0] op_sel_hi:[1,0]
  v_pk_mul_f32 v[142:143], v[126:127], v[124:125] op_sel:[0,0] op_sel_hi:[1,0]
  v_pk_mul_f32 v[170:171], v[154:155], v[152:153] op_sel:[0,0] op_sel_hi:[1,0]
  v_pk_fma_f32 v[70:71], v[70:71], v[68:69], v[86:87] op_sel:[1,1,0] op_sel_hi:[0,1,1] neg_lo:[1,0,0]
  v_pk_fma_f32 v[98:99], v[98:99], v[96:97], v[114:115] op_sel:[1,1,0] op_sel_hi:[0,1,1] neg_lo:[1,0,0]
  v_pk_fma_f32 v[126:127], v[126:127], v[124:125], v[142:143] op_sel:[1,1,0] op_sel_hi:[0,1,1] neg_lo:[1,0,0]
  v_pk_fma_f32 v[154:155], v[154:155], v[152:153], v[170:171] op_sel:[1,1,0] op_sel_hi:[0,1,1] neg_lo:[1,0,0]
  v_cvt_pk_bf16_f32 v180, v70, v71
  v_cvt_pk_bf16_f32 v181, v98, v99
  v_cvt_pk_bf16_f32 v182, v126, v127
  v_cvt_pk_bf16_f32 v183, v154, v155
  ds_write_b128 v51, v[180:183] offset:9360
  v_pk_mul_f32 v[86:87], v[70:71], v[68:69] op_sel:[0,0] op_sel_hi:[1,0]
  v_pk_mul_f32 v[114:115], v[98:99], v[96:97] op_sel:[0,0] op_sel_hi:[1,0]
  v_pk_mul_f32 v[142:143], v[126:127], v[124:125] op_sel:[0,0] op_sel_hi:[1,0]
  v_pk_mul_f32 v[170:171], v[154:155], v[152:153] op_sel:[0,0] op_sel_hi:[1,0]
  v_pk_fma_f32 v[70:71], v[70:71], v[68:69], v[86:87] op_sel:[1,1,0] op_sel_hi:[0,1,1] neg_lo:[1,0,0]
  v_pk_fma_f32 v[98:99], v[98:99], v[96:97], v[114:115] op_sel:[1,1,0] op_sel_hi:[0,1,1] neg_lo:[1,0,0]
  v_pk_fma_f32 v[126:127], v[126:127], v[124:125], v[142:143] op_sel:[1,1,0] op_sel_hi:[0,1,1] neg_lo:[1,0,0]
  v_pk_fma_f32 v[154:155], v[154:155], v[152:153], v[170:171] op_sel:[1,1,0] op_sel_hi:[0,1,1] neg_lo:[1,0,0]
  v_cvt_pk_bf16_f32 v176, v70, v71
  v_cvt_pk_bf16_f32 v177, v98, v99
  v_cvt_pk_bf16_f32 v178, v126, v127
  v_cvt_pk_bf16_f32 v179, v154, v155
  ds_write_b128 v51, v[176:179] offset:10400
  v_pk_mul_f32 v[86:87], v[70:71], v[68:69] op_sel:[0,0] op_sel_hi:[1,0]
  v_pk_mul_f32 v[114:115], v[98:99], v[96:97] op_sel:[0,0] op_sel_hi:[1,0]
  v_pk_mul_f32 v[142:143], v[126:127], v[124:125] op_sel:[0,0] op_sel_hi:[1,0]
  v_pk_mul_f32 v[170:171], v[154:155], v[152:153] op_sel:[0,0] op_sel_hi:[1,0]
  v_pk_fma_f32 v[70:71], v[70:71], v[68:69], v[86:87] op_sel:[1,1,0] op_sel_hi:[0,1,1] neg_lo:[1,0,0]
  v_pk_fma_f32 v[98:99], v[98:99], v[96:97], v[114:115] op_sel:[1,1,0] op_sel_hi:[0,1,1] neg_lo:[1,0,0]
  v_pk_fma_f32 v[126:127], v[126:127], v[124:125], v[142:143] op_sel:[1,1,0] op_sel_hi:[0,1,1] neg_lo:[1,0,0]
  v_pk_fma_f32 v[154:155], v[154:155], v[152:153], v[170:171] op_sel:[1,1,0] op_sel_hi:[0,1,1] neg_lo:[1,0,0]
  v_cvt_pk_bf16_f32 v180, v70, v71
  v_cvt_pk_bf16_f32 v181, v98, v99
  v_cvt_pk_bf16_f32 v182, v126, v127
  v_cvt_pk_bf16_f32 v183, v154, v155
  ds_write_b128 v51, v[180:183] offset:11440
  v_pk_mul_f32 v[86:87], v[70:71], v[68:69] op_sel:[0,0] op_sel_hi:[1,0]
  v_pk_mul_f32 v[114:115], v[98:99], v[96:97] op_sel:[0,0] op_sel_hi:[1,0]
  v_pk_mul_f32 v[142:143], v[126:127], v[124:125] op_sel:[0,0] op_sel_hi:[1,0]
  v_pk_mul_f32 v[170:171], v[154:155], v[152:153] op_sel:[0,0] op_sel_hi:[1,0]
  v_pk_fma_f32 v[70:71], v[70:71], v[68:69], v[86:87] op_sel:[1,1,0] op_sel_hi:[0,1,1] neg_lo:[1,0,0]
  v_pk_fma_f32 v[98:99], v[98:99], v[96:97], v[114:115] op_sel:[1,1,0] op_sel_hi:[0,1,1] neg_lo:[1,0,0]
  v_pk_fma_f32 v[126:127], v[126:127], v[124:125], v[142:143] op_sel:[1,1,0] op_sel_hi:[0,1,1] neg_lo:[1,0,0]
  v_pk_fma_f32 v[154:155], v[154:155], v[152:153], v[170:171] op_sel:[1,1,0] op_sel_hi:[0,1,1] neg_lo:[1,0,0]
  v_cvt_pk_bf16_f32 v176, v70, v71
  v_cvt_pk_bf16_f32 v177, v98, v99
  v_cvt_pk_bf16_f32 v178, v126, v127
  v_cvt_pk_bf16_f32 v179, v154, v155
  ds_write_b128 v51, v[176:179] offset:12480
  v_pk_mul_f32 v[86:87], v[70:71], v[68:69] op_sel:[0,0] op_sel_hi:[1,0]
  v_pk_mul_f32 v[114:115], v[98:99], v[96:97] op_sel:[0,0] op_sel_hi:[1,0]
  v_pk_mul_f32 v[142:143], v[126:127], v[124:125] op_sel:[0,0] op_sel_hi:[1,0]
  v_pk_mul_f32 v[170:171], v[154:155], v[152:153] op_sel:[0,0] op_sel_hi:[1,0]
  v_pk_fma_f32 v[70:71], v[70:71], v[68:69], v[86:87] op_sel:[1,1,0] op_sel_hi:[0,1,1] neg_lo:[1,0,0]
  v_pk_fma_f32 v[98:99], v[98:99], v[96:97], v[114:115] op_sel:[1,1,0] op_sel_hi:[0,1,1] neg_lo:[1,0,0]
  v_pk_fma_f32 v[126:127], v[126:127], v[124:125], v[142:143] op_sel:[1,1,0] op_sel_hi:[0,1,1] neg_lo:[1,0,0]
  v_pk_fma_f32 v[154:155], v[154:155], v[152:153], v[170:171] op_sel:[1,1,0] op_sel_hi:[0,1,1] neg_lo:[1,0,0]
  v_cvt_pk_bf16_f32 v180, v70, v71
  v_cvt_pk_bf16_f32 v181, v98, v99
  v_cvt_pk_bf16_f32 v182, v126, v127
  v_cvt_pk_bf16_f32 v183, v154, v155
  ds_write_b128 v51, v[180:183] offset:13520
  v_pk_mul_f32 v[86:87], v[70:71], v[68:69] op_sel:[0,0] op_sel_hi:[1,0]
  v_pk_mul_f32 v[114:115], v[98:99], v[96:97] op_sel:[0,0] op_sel_hi:[1,0]
  v_pk_mul_f32 v[142:143], v[126:127], v[124:125] op_sel:[0,0] op_sel_hi:[1,0]
  v_pk_mul_f32 v[170:171], v[154:155], v[152:153] op_sel:[0,0] op_sel_hi:[1,0]
  v_pk_fma_f32 v[70:71], v[70:71], v[68:69], v[86:87] op_sel:[1,1,0] op_sel_hi:[0,1,1] neg_lo:[1,0,0]
  v_pk_fma_f32 v[98:99], v[98:99], v[96:97], v[114:115] op_sel:[1,1,0] op_sel_hi:[0,1,1] neg_lo:[1,0,0]
  v_pk_fma_f32 v[126:127], v[126:127], v[124:125], v[142:143] op_sel:[1,1,0] op_sel_hi:[0,1,1] neg_lo:[1,0,0]
  v_pk_fma_f32 v[154:155], v[154:155], v[152:153], v[170:171] op_sel:[1,1,0] op_sel_hi:[0,1,1] neg_lo:[1,0,0]
  v_cvt_pk_bf16_f32 v176, v70, v71
  v_cvt_pk_bf16_f32 v177, v98, v99
  v_cvt_pk_bf16_f32 v178, v126, v127
  v_cvt_pk_bf16_f32 v179, v154, v155
  ds_write_b128 v51, v[176:179] offset:14560
  v_pk_mul_f32 v[86:87], v[70:71], v[68:69] op_sel:[0,0] op_sel_hi:[1,0]
  v_pk_mul_f32 v[114:115], v[98:99], v[96:97] op_sel:[0,0] op_sel_hi:[1,0]
  v_pk_mul_f32 v[142:143], v[126:127], v[124:125] op_sel:[0,0] op_sel_hi:[1,0]
  v_pk_mul_f32 v[170:171], v[154:155], v[152:153] op_sel:[0,0] op_sel_hi:[1,0]
  v_pk_fma_f32 v[70:71], v[70:71], v[68:69], v[86:87] op_sel:[1,1,0] op_sel_hi:[0,1,1] neg_lo:[1,0,0]
  v_pk_fma_f32 v[98:99], v[98:99], v[96:97], v[114:115] op_sel:[1,1,0] op_sel_hi:[0,1,1] neg_lo:[1,0,0]
  v_pk_fma_f32 v[126:127], v[126:127], v[124:125], v[142:143] op_sel:[1,1,0] op_sel_hi:[0,1,1] neg_lo:[1,0,0]
  v_pk_fma_f32 v[154:155], v[154:155], v[152:153], v[170:171] op_sel:[1,1,0] op_sel_hi:[0,1,1] neg_lo:[1,0,0]
  v_cvt_pk_bf16_f32 v180, v70, v71
  v_cvt_pk_bf16_f32 v181, v98, v99
  v_cvt_pk_bf16_f32 v182, v126, v127
  v_cvt_pk_bf16_f32 v183, v154, v155
  ds_write_b128 v51, v[180:183] offset:15600
  v_pk_mul_f32 v[86:87], v[70:71], v[68:69] op_sel:[0,0] op_sel_hi:[1,0]
  v_pk_mul_f32 v[114:115], v[98:99], v[96:97] op_sel:[0,0] op_sel_hi:[1,0]
  v_pk_mul_f32 v[142:143], v[126:127], v[124:125] op_sel:[0,0] op_sel_hi:[1,0]
  v_pk_mul_f32 v[170:171], v[154:155], v[152:153] op_sel:[0,0] op_sel_hi:[1,0]
  v_pk_fma_f32 v[70:71], v[70:71], v[68:69], v[86:87] op_sel:[1,1,0] op_sel_hi:[0,1,1] neg_lo:[1,0,0]
  v_pk_fma_f32 v[98:99], v[98:99], v[96:97], v[114:115] op_sel:[1,1,0] op_sel_hi:[0,1,1] neg_lo:[1,0,0]
  v_pk_fma_f32 v[126:127], v[126:127], v[124:125], v[142:143] op_sel:[1,1,0] op_sel_hi:[0,1,1] neg_lo:[1,0,0]
  v_pk_fma_f32 v[154:155], v[154:155], v[152:153], v[170:171] op_sel:[1,1,0] op_sel_hi:[0,1,1] neg_lo:[1,0,0]
  v_cvt_pk_bf16_f32 v176, v70, v71
  v_cvt_pk_bf16_f32 v177, v98, v99
  v_cvt_pk_bf16_f32 v178, v126, v127
  v_cvt_pk_bf16_f32 v179, v154, v155
  ds_write_b128 v51, v[176:179] offset:16640
  v_pk_mul_f32 v[86:87], v[70:71], v[68:69] op_sel:[0,0] op_sel_hi:[1,0]
  v_pk_mul_f32 v[114:115], v[98:99], v[96:97] op_sel:[0,0] op_sel_hi:[1,0]
  v_pk_mul_f32 v[142:143], v[126:127], v[124:125] op_sel:[0,0] op_sel_hi:[1,0]
  v_pk_mul_f32 v[170:171], v[154:155], v[152:153] op_sel:[0,0] op_sel_hi:[1,0]
  v_pk_fma_f32 v[70:71], v[70:71], v[68:69], v[86:87] op_sel:[1,1,0] op_sel_hi:[0,1,1] neg_lo:[1,0,0]
  v_pk_fma_f32 v[98:99], v[98:99], v[96:97], v[114:115] op_sel:[1,1,0] op_sel_hi:[0,1,1] neg_lo:[1,0,0]
  v_pk_fma_f32 v[126:127], v[126:127], v[124:125], v[142:143] op_sel:[1,1,0] op_sel_hi:[0,1,1] neg_lo:[1,0,0]
  v_pk_fma_f32 v[154:155], v[154:155], v[152:153], v[170:171] op_sel:[1,1,0] op_sel_hi:[0,1,1] neg_lo:[1,0,0]
  v_cvt_pk_bf16_f32 v180, v70, v71
  v_cvt_pk_bf16_f32 v181, v98, v99
  v_cvt_pk_bf16_f32 v182, v126, v127
  v_cvt_pk_bf16_f32 v183, v154, v155
  ds_write_b128 v51, v[180:183] offset:17680
  v_pk_mul_f32 v[86:87], v[70:71], v[68:69] op_sel:[0,0] op_sel_hi:[1,0]
  v_pk_mul_f32 v[114:115], v[98:99], v[96:97] op_sel:[0,0] op_sel_hi:[1,0]
  v_pk_mul_f32 v[142:143], v[126:127], v[124:125] op_sel:[0,0] op_sel_hi:[1,0]
  v_pk_mul_f32 v[170:171], v[154:155], v[152:153] op_sel:[0,0] op_sel_hi:[1,0]
  v_pk_fma_f32 v[70:71], v[70:71], v[68:69], v[86:87] op_sel:[1,1,0] op_sel_hi:[0,1,1] neg_lo:[1,0,0]
  v_pk_fma_f32 v[98:99], v[98:99], v[96:97], v[114:115] op_sel:[1,1,0] op_sel_hi:[0,1,1] neg_lo:[1,0,0]
  v_pk_fma_f32 v[126:127], v[126:127], v[124:125], v[142:143] op_sel:[1,1,0] op_sel_hi:[0,1,1] neg_lo:[1,0,0]
  v_pk_fma_f32 v[154:155], v[154:155], v[152:153], v[170:171] op_sel:[1,1,0] op_sel_hi:[0,1,1] neg_lo:[1,0,0]
  v_cvt_pk_bf16_f32 v176, v70, v71
  v_cvt_pk_bf16_f32 v177, v98, v99
  v_cvt_pk_bf16_f32 v178, v126, v127
  v_cvt_pk_bf16_f32 v179, v154, v155
  ds_write_b128 v51, v[176:179] offset:18720
  v_pk_mul_f32 v[86:87], v[70:71], v[68:69] op_sel:[0,0] op_sel_hi:[1,0]
  v_pk_mul_f32 v[114:115], v[98:99], v[96:97] op_sel:[0,0] op_sel_hi:[1,0]
  v_pk_mul_f32 v[142:143], v[126:127], v[124:125] op_sel:[0,0] op_sel_hi:[1,0]
  v_pk_mul_f32 v[170:171], v[154:155], v[152:153] op_sel:[0,0] op_sel_hi:[1,0]
  v_pk_fma_f32 v[70:71], v[70:71], v[68:69], v[86:87] op_sel:[1,1,0] op_sel_hi:[0,1,1] neg_lo:[1,0,0]
  v_pk_fma_f32 v[98:99], v[98:99], v[96:97], v[114:115] op_sel:[1,1,0] op_sel_hi:[0,1,1] neg_lo:[1,0,0]
  v_pk_fma_f32 v[126:127], v[126:127], v[124:125], v[142:143] op_sel:[1,1,0] op_sel_hi:[0,1,1] neg_lo:[1,0,0]
  v_pk_fma_f32 v[154:155], v[154:155], v[152:153], v[170:171] op_sel:[1,1,0] op_sel_hi:[0,1,1] neg_lo:[1,0,0]
  v_cvt_pk_bf16_f32 v180, v70, v71
  v_cvt_pk_bf16_f32 v181, v98, v99
  v_cvt_pk_bf16_f32 v182, v126, v127
  v_cvt_pk_bf16_f32 v183, v154, v155
  ds_write_b128 v51, v[180:183] offset:19760
  v_pk_mul_f32 v[86:87], v[70:71], v[68:69] op_sel:[0,0] op_sel_hi:[1,0]
  v_pk_mul_f32 v[114:115], v[98:99], v[96:97] op_sel:[0,0] op_sel_hi:[1,0]
  v_pk_mul_f32 v[142:143], v[126:127], v[124:125] op_sel:[0,0] op_sel_hi:[1,0]
  v_pk_mul_f32 v[170:171], v[154:155], v[152:153] op_sel:[0,0] op_sel_hi:[1,0]
  v_pk_fma_f32 v[70:71], v[70:71], v[68:69], v[86:87] op_sel:[1,1,0] op_sel_hi:[0,1,1] neg_lo:[1,0,0]
  v_pk_fma_f32 v[98:99], v[98:99], v[96:97], v[114:115] op_sel:[1,1,0] op_sel_hi:[0,1,1] neg_lo:[1,0,0]
  v_pk_fma_f32 v[126:127], v[126:127], v[124:125], v[142:143] op_sel:[1,1,0] op_sel_hi:[0,1,1] neg_lo:[1,0,0]
  v_pk_fma_f32 v[154:155], v[154:155], v[152:153], v[170:171] op_sel:[1,1,0] op_sel_hi:[0,1,1] neg_lo:[1,0,0]
  v_cvt_pk_bf16_f32 v176, v70, v71
  v_cvt_pk_bf16_f32 v177, v98, v99
  v_cvt_pk_bf16_f32 v178, v126, v127
  v_cvt_pk_bf16_f32 v179, v154, v155
  ds_write_b128 v51, v[176:179] offset:20800
  v_pk_mul_f32 v[86:87], v[70:71], v[68:69] op_sel:[0,0] op_sel_hi:[1,0]
  v_pk_mul_f32 v[114:115], v[98:99], v[96:97] op_sel:[0,0] op_sel_hi:[1,0]
  v_pk_mul_f32 v[142:143], v[126:127], v[124:125] op_sel:[0,0] op_sel_hi:[1,0]
  v_pk_mul_f32 v[170:171], v[154:155], v[152:153] op_sel:[0,0] op_sel_hi:[1,0]
  v_pk_fma_f32 v[70:71], v[70:71], v[68:69], v[86:87] op_sel:[1,1,0] op_sel_hi:[0,1,1] neg_lo:[1,0,0]
  v_pk_fma_f32 v[98:99], v[98:99], v[96:97], v[114:115] op_sel:[1,1,0] op_sel_hi:[0,1,1] neg_lo:[1,0,0]
  v_pk_fma_f32 v[126:127], v[126:127], v[124:125], v[142:143] op_sel:[1,1,0] op_sel_hi:[0,1,1] neg_lo:[1,0,0]
  v_pk_fma_f32 v[154:155], v[154:155], v[152:153], v[170:171] op_sel:[1,1,0] op_sel_hi:[0,1,1] neg_lo:[1,0,0]
  v_cvt_pk_bf16_f32 v180, v70, v71
  v_cvt_pk_bf16_f32 v181, v98, v99
  v_cvt_pk_bf16_f32 v182, v126, v127
  v_cvt_pk_bf16_f32 v183, v154, v155
  ds_write_b128 v51, v[180:183] offset:21840
  v_pk_mul_f32 v[86:87], v[70:71], v[68:69] op_sel:[0,0] op_sel_hi:[1,0]
  v_pk_mul_f32 v[114:115], v[98:99], v[96:97] op_sel:[0,0] op_sel_hi:[1,0]
  v_pk_mul_f32 v[142:143], v[126:127], v[124:125] op_sel:[0,0] op_sel_hi:[1,0]
  v_pk_mul_f32 v[170:171], v[154:155], v[152:153] op_sel:[0,0] op_sel_hi:[1,0]
  v_pk_fma_f32 v[70:71], v[70:71], v[68:69], v[86:87] op_sel:[1,1,0] op_sel_hi:[0,1,1] neg_lo:[1,0,0]
  v_pk_fma_f32 v[98:99], v[98:99], v[96:97], v[114:115] op_sel:[1,1,0] op_sel_hi:[0,1,1] neg_lo:[1,0,0]
  v_pk_fma_f32 v[126:127], v[126:127], v[124:125], v[142:143] op_sel:[1,1,0] op_sel_hi:[0,1,1] neg_lo:[1,0,0]
  v_pk_fma_f32 v[154:155], v[154:155], v[152:153], v[170:171] op_sel:[1,1,0] op_sel_hi:[0,1,1] neg_lo:[1,0,0]
  v_cvt_pk_bf16_f32 v176, v70, v71
  v_cvt_pk_bf16_f32 v177, v98, v99
  v_cvt_pk_bf16_f32 v178, v126, v127
  v_cvt_pk_bf16_f32 v179, v154, v155
  ds_write_b128 v51, v[176:179] offset:22880
  v_pk_mul_f32 v[86:87], v[70:71], v[68:69] op_sel:[0,0] op_sel_hi:[1,0]
  v_pk_mul_f32 v[114:115], v[98:99], v[96:97] op_sel:[0,0] op_sel_hi:[1,0]
  v_pk_mul_f32 v[142:143], v[126:127], v[124:125] op_sel:[0,0] op_sel_hi:[1,0]
  v_pk_mul_f32 v[170:171], v[154:155], v[152:153] op_sel:[0,0] op_sel_hi:[1,0]
  v_pk_fma_f32 v[70:71], v[70:71], v[68:69], v[86:87] op_sel:[1,1,0] op_sel_hi:[0,1,1] neg_lo:[1,0,0]
  v_pk_fma_f32 v[98:99], v[98:99], v[96:97], v[114:115] op_sel:[1,1,0] op_sel_hi:[0,1,1] neg_lo:[1,0,0]
  v_pk_fma_f32 v[126:127], v[126:127], v[124:125], v[142:143] op_sel:[1,1,0] op_sel_hi:[0,1,1] neg_lo:[1,0,0]
  v_pk_fma_f32 v[154:155], v[154:155], v[152:153], v[170:171] op_sel:[1,1,0] op_sel_hi:[0,1,1] neg_lo:[1,0,0]
  v_cvt_pk_bf16_f32 v180, v70, v71
  v_cvt_pk_bf16_f32 v181, v98, v99
  v_cvt_pk_bf16_f32 v182, v126, v127
  v_cvt_pk_bf16_f32 v183, v154, v155
  ds_write_b128 v51, v[180:183] offset:23920
  v_pk_mul_f32 v[86:87], v[70:71], v[68:69] op_sel:[0,0] op_sel_hi:[1,0]
  v_pk_mul_f32 v[114:115], v[98:99], v[96:97] op_sel:[0,0] op_sel_hi:[1,0]
  v_pk_mul_f32 v[142:143], v[126:127], v[124:125] op_sel:[0,0] op_sel_hi:[1,0]
  v_pk_mul_f32 v[170:171], v[154:155], v[152:153] op_sel:[0,0] op_sel_hi:[1,0]
  v_pk_fma_f32 v[70:71], v[70:71], v[68:69], v[86:87] op_sel:[1,1,0] op_sel_hi:[0,1,1] neg_lo:[1,0,0]
  v_pk_fma_f32 v[98:99], v[98:99], v[96:97], v[114:115] op_sel:[1,1,0] op_sel_hi:[0,1,1] neg_lo:[1,0,0]
  v_pk_fma_f32 v[126:127], v[126:127], v[124:125], v[142:143] op_sel:[1,1,0] op_sel_hi:[0,1,1] neg_lo:[1,0,0]
  global_load_dword v226, v224, s[36:37]
  global_load_dword v227, v224, s[38:39]
  v_pk_fma_f32 v[154:155], v[154:155], v[152:153], v[170:171] op_sel:[1,1,0] op_sel_hi:[0,1,1] neg_lo:[1,0,0]
  v_cvt_pk_bf16_f32 v176, v70, v71
  v_cvt_pk_bf16_f32 v177, v98, v99
  v_cvt_pk_bf16_f32 v178, v126, v127
  v_cvt_pk_bf16_f32 v179, v154, v155
  ds_write_b128 v51, v[176:179] offset:24960
  v_pk_mul_f32 v[86:87], v[70:71], v[68:69] op_sel:[0,0] op_sel_hi:[1,0]
  v_pk_mul_f32 v[114:115], v[98:99], v[96:97] op_sel:[0,0] op_sel_hi:[1,0]
  v_pk_mul_f32 v[142:143], v[126:127], v[124:125] op_sel:[0,0] op_sel_hi:[1,0]
  v_pk_mul_f32 v[170:171], v[154:155], v[152:153] op_sel:[0,0] op_sel_hi:[1,0]
  v_pk_fma_f32 v[70:71], v[70:71], v[68:69], v[86:87] op_sel:[1,1,0] op_sel_hi:[0,1,1] neg_lo:[1,0,0]
  v_pk_fma_f32 v[98:99], v[98:99], v[96:97], v[114:115] op_sel:[1,1,0] op_sel_hi:[0,1,1] neg_lo:[1,0,0]
  v_pk_fma_f32 v[126:127], v[126:127], v[124:125], v[142:143] op_sel:[1,1,0] op_sel_hi:[0,1,1] neg_lo:[1,0,0]
  v_pk_fma_f32 v[154:155], v[154:155], v[152:153], v[170:171] op_sel:[1,1,0] op_sel_hi:[0,1,1] neg_lo:[1,0,0]
  v_cvt_pk_bf16_f32 v180, v70, v71
  v_cvt_pk_bf16_f32 v181, v98, v99
  v_cvt_pk_bf16_f32 v182, v126, v127
  v_cvt_pk_bf16_f32 v183, v154, v155
  ds_write_b128 v51, v[180:183] offset:26000
  v_pk_mul_f32 v[86:87], v[70:71], v[68:69] op_sel:[0,0] op_sel_hi:[1,0]
  v_pk_mul_f32 v[114:115], v[98:99], v[96:97] op_sel:[0,0] op_sel_hi:[1,0]
  v_pk_mul_f32 v[142:143], v[126:127], v[124:125] op_sel:[0,0] op_sel_hi:[1,0]
  v_pk_mul_f32 v[170:171], v[154:155], v[152:153] op_sel:[0,0] op_sel_hi:[1,0]
  v_pk_fma_f32 v[70:71], v[70:71], v[68:69], v[86:87] op_sel:[1,1,0] op_sel_hi:[0,1,1] neg_lo:[1,0,0]
  v_pk_fma_f32 v[98:99], v[98:99], v[96:97], v[114:115] op_sel:[1,1,0] op_sel_hi:[0,1,1] neg_lo:[1,0,0]
  v_pk_fma_f32 v[126:127], v[126:127], v[124:125], v[142:143] op_sel:[1,1,0] op_sel_hi:[0,1,1] neg_lo:[1,0,0]
  v_pk_fma_f32 v[154:155], v[154:155], v[152:153], v[170:171] op_sel:[1,1,0] op_sel_hi:[0,1,1] neg_lo:[1,0,0]
  v_cvt_pk_bf16_f32 v176, v70, v71
  v_cvt_pk_bf16_f32 v177, v98, v99
  v_cvt_pk_bf16_f32 v178, v126, v127
  v_cvt_pk_bf16_f32 v179, v154, v155
  ds_write_b128 v51, v[176:179] offset:27040
  v_pk_mul_f32 v[86:87], v[70:71], v[68:69] op_sel:[0,0] op_sel_hi:[1,0]
  v_pk_mul_f32 v[114:115], v[98:99], v[96:97] op_sel:[0,0] op_sel_hi:[1,0]
  v_pk_mul_f32 v[142:143], v[126:127], v[124:125] op_sel:[0,0] op_sel_hi:[1,0]
  v_pk_mul_f32 v[170:171], v[154:155], v[152:153] op_sel:[0,0] op_sel_hi:[1,0]
  v_pk_fma_f32 v[70:71], v[70:71], v[68:69], v[86:87] op_sel:[1,1,0] op_sel_hi:[0,1,1] neg_lo:[1,0,0]
  v_pk_fma_f32 v[98:99], v[98:99], v[96:97], v[114:115] op_sel:[1,1,0] op_sel_hi:[0,1,1] neg_lo:[1,0,0]
  v_pk_fma_f32 v[126:127], v[126:127], v[124:125], v[142:143] op_sel:[1,1,0] op_sel_hi:[0,1,1] neg_lo:[1,0,0]
  v_pk_fma_f32 v[154:155], v[154:155], v[152:153], v[170:171] op_sel:[1,1,0] op_sel_hi:[0,1,1] neg_lo:[1,0,0]
  v_cvt_pk_bf16_f32 v180, v70, v71
  v_cvt_pk_bf16_f32 v181, v98, v99
  v_cvt_pk_bf16_f32 v182, v126, v127
  v_cvt_pk_bf16_f32 v183, v154, v155
  ds_write_b128 v51, v[180:183] offset:28080
  v_pk_mul_f32 v[86:87], v[70:71], v[68:69] op_sel:[0,0] op_sel_hi:[1,0]
  v_pk_mul_f32 v[114:115], v[98:99], v[96:97] op_sel:[0,0] op_sel_hi:[1,0]
  v_pk_mul_f32 v[142:143], v[126:127], v[124:125] op_sel:[0,0] op_sel_hi:[1,0]
  v_pk_mul_f32 v[170:171], v[154:155], v[152:153] op_sel:[0,0] op_sel_hi:[1,0]
  v_pk_fma_f32 v[70:71], v[70:71], v[68:69], v[86:87] op_sel:[1,1,0] op_sel_hi:[0,1,1] neg_lo:[1,0,0]
  v_pk_fma_f32 v[98:99], v[98:99], v[96:97], v[114:115] op_sel:[1,1,0] op_sel_hi:[0,1,1] neg_lo:[1,0,0]
  v_pk_fma_f32 v[126:127], v[126:127], v[124:125], v[142:143] op_sel:[1,1,0] op_sel_hi:[0,1,1] neg_lo:[1,0,0]
  v_pk_fma_f32 v[154:155], v[154:155], v[152:153], v[170:171] op_sel:[1,1,0] op_sel_hi:[0,1,1] neg_lo:[1,0,0]
  v_cvt_pk_bf16_f32 v176, v70, v71
  v_cvt_pk_bf16_f32 v177, v98, v99
  v_cvt_pk_bf16_f32 v178, v126, v127
  v_cvt_pk_bf16_f32 v179, v154, v155
  ds_write_b128 v51, v[176:179] offset:29120
  v_pk_mul_f32 v[86:87], v[70:71], v[68:69] op_sel:[0,0] op_sel_hi:[1,0]
  v_pk_mul_f32 v[114:115], v[98:99], v[96:97] op_sel:[0,0] op_sel_hi:[1,0]
  v_pk_mul_f32 v[142:143], v[126:127], v[124:125] op_sel:[0,0] op_sel_hi:[1,0]
  v_pk_mul_f32 v[170:171], v[154:155], v[152:153] op_sel:[0,0] op_sel_hi:[1,0]
  v_pk_fma_f32 v[70:71], v[70:71], v[68:69], v[86:87] op_sel:[1,1,0] op_sel_hi:[0,1,1] neg_lo:[1,0,0]
  v_pk_fma_f32 v[98:99], v[98:99], v[96:97], v[114:115] op_sel:[1,1,0] op_sel_hi:[0,1,1] neg_lo:[1,0,0]
  v_pk_fma_f32 v[126:127], v[126:127], v[124:125], v[142:143] op_sel:[1,1,0] op_sel_hi:[0,1,1] neg_lo:[1,0,0]
  v_pk_fma_f32 v[154:155], v[154:155], v[152:153], v[170:171] op_sel:[1,1,0] op_sel_hi:[0,1,1] neg_lo:[1,0,0]
  v_cvt_pk_bf16_f32 v180, v70, v71
  v_cvt_pk_bf16_f32 v181, v98, v99
  v_cvt_pk_bf16_f32 v182, v126, v127
  v_cvt_pk_bf16_f32 v183, v154, v155
  ds_write_b128 v51, v[180:183] offset:30160
  v_pk_mul_f32 v[86:87], v[70:71], v[68:69] op_sel:[0,0] op_sel_hi:[1,0]
  v_pk_mul_f32 v[114:115], v[98:99], v[96:97] op_sel:[0,0] op_sel_hi:[1,0]
  v_pk_mul_f32 v[142:143], v[126:127], v[124:125] op_sel:[0,0] op_sel_hi:[1,0]
  v_pk_mul_f32 v[170:171], v[154:155], v[152:153] op_sel:[0,0] op_sel_hi:[1,0]
  v_pk_fma_f32 v[70:71], v[70:71], v[68:69], v[86:87] op_sel:[1,1,0] op_sel_hi:[0,1,1] neg_lo:[1,0,0]
  v_pk_fma_f32 v[98:99], v[98:99], v[96:97], v[114:115] op_sel:[1,1,0] op_sel_hi:[0,1,1] neg_lo:[1,0,0]
  v_pk_fma_f32 v[126:127], v[126:127], v[124:125], v[142:143] op_sel:[1,1,0] op_sel_hi:[0,1,1] neg_lo:[1,0,0]
  v_pk_fma_f32 v[154:155], v[154:155], v[152:153], v[170:171] op_sel:[1,1,0] op_sel_hi:[0,1,1] neg_lo:[1,0,0]
  v_cvt_pk_bf16_f32 v176, v70, v71
  v_cvt_pk_bf16_f32 v177, v98, v99
  v_cvt_pk_bf16_f32 v178, v126, v127
  v_cvt_pk_bf16_f32 v179, v154, v155
  ds_write_b128 v51, v[176:179] offset:31200
  v_pk_mul_f32 v[86:87], v[70:71], v[68:69] op_sel:[0,0] op_sel_hi:[1,0]
  v_pk_mul_f32 v[114:115], v[98:99], v[96:97] op_sel:[0,0] op_sel_hi:[1,0]
  v_pk_mul_f32 v[142:143], v[126:127], v[124:125] op_sel:[0,0] op_sel_hi:[1,0]
  v_pk_mul_f32 v[170:171], v[154:155], v[152:153] op_sel:[0,0] op_sel_hi:[1,0]
  v_pk_fma_f32 v[70:71], v[70:71], v[68:69], v[86:87] op_sel:[1,1,0] op_sel_hi:[0,1,1] neg_lo:[1,0,0]
  v_pk_fma_f32 v[98:99], v[98:99], v[96:97], v[114:115] op_sel:[1,1,0] op_sel_hi:[0,1,1] neg_lo:[1,0,0]
  v_pk_fma_f32 v[126:127], v[126:127], v[124:125], v[142:143] op_sel:[1,1,0] op_sel_hi:[0,1,1] neg_lo:[1,0,0]
  v_pk_fma_f32 v[154:155], v[154:155], v[152:153], v[170:171] op_sel:[1,1,0] op_sel_hi:[0,1,1] neg_lo:[1,0,0]
  v_cvt_pk_bf16_f32 v180, v70, v71
  v_cvt_pk_bf16_f32 v181, v98, v99
  v_cvt_pk_bf16_f32 v182, v126, v127
  v_cvt_pk_bf16_f32 v183, v154, v155
  ds_write_b128 v51, v[180:183] offset:32240
L_kdone:
  s_waitcnt lgkmcnt(0)
  s_barrier
  ds_read_b128 v[64:67], v53 offset:0
  ds_read_b128 v[68:71], v52 offset:33280
  ds_read_b128 v[72:75], v52 offset:49920
  ds_read_b128 v[76:79], v53 offset:16
  ds_read_b128 v[80:83], v52 offset:33296
  ds_read_b128 v[84:87], v52 offset:49936
  ds_read_b128 v[88:91], v53 offset:32
  ds_read_b128 v[92:95], v52 offset:33312
  ds_read_b128 v[96:99], v52 offset:49952
  ds_read_b128 v[100:103], v53 offset:48
  ds_read_b128 v[104:107], v52 offset:33328
  ds_read_b128 v[108:111], v52 offset:49968
  ds_read_b128 v[112:115], v53 offset:64
  ds_read_b128 v[116:119], v52 offset:33344
  ds_read_b128 v[120:123], v52 offset:49984
  s_waitcnt lgkmcnt(13)
  v_mfma_f32_16x16x32_bf16 v[12:15], v[68:71], v[64:67], 0
  s_waitcnt lgkmcnt(12)
  v_mfma_f32_16x16x32_bf16 v[16:19], v[72:75], v[64:67], 0
  ds_read_b128 v[124:127], v53 offset:80
  ds_read_b128 v[128:131], v52 offset:33360
  ds_read_b128 v[132:135], v52 offset:50000
  s_waitcnt lgkmcnt(13)
  v_mfma_f32_16x16x32_bf16 v[12:15], v[80:83], v[76:79], v[12:15]
  s_waitcnt lgkmcnt(12)
  v_mfma_f32_16x16x32_bf16 v[16:19], v[84:87], v[76:79], v[16:19]
  ds_read_b128 v[136:139], v53 offset:96
  ds_read_b128 v[140:143], v52 offset:33376
  ds_read_b128 v[144:147], v52 offset:50016
  s_waitcnt lgkmcnt(13)
  v_mfma_f32_16x16x32_bf16 v[12:15], v[92:95], v[88:91], v[12:15]
  s_waitcnt lgkmcnt(12)
  v_mfma_f32_16x16x32_bf16 v[16:19], v[96:99], v[88:91], v[16:19]
  ds_read_b128 v[148:151], v53 offset:112
  ds_read_b128 v[152:155], v52 offset:33392
  ds_read_b128 v[156:159], v52 offset:50032
  global_load_dwordx4 v[160:163], v62, s[48:49] offset:-4096 sc1
  s_waitcnt lgkmcnt(13)
  v_mfma_f32_16x16x32_bf16 v[12:15], v[104:107], v[100:103], v[12:15]
  s_waitcnt lgkmcnt(12)
  v_mfma_f32_16x16x32_bf16 v[16:19], v[108:111], v[100:103], v[16:19]
  ds_read_b128 v[64:67], v53 offset:128
  ds_read_b128 v[68:71], v52 offset:33408
  ds_read_b128 v[72:75], v52 offset:50048
  global_load_dwordx4 v[164:167], v62, s[48:49] offset:0 sc1
  s_waitcnt lgkmcnt(13)
  v_mfma_f32_16x16x32_bf16 v[12:15], v[116:119], v[112:115], v[12:15]
  s_waitcnt lgkmcnt(12)
  v_mfma_f32_16x16x32_bf16 v[16:19], v[120:123], v[112:115], v[16:19]
  ds_read_b128 v[76:79], v53 offset:144
  ds_read_b128 v[80:83], v52 offset:33424
  ds_read_b128 v[84:87], v52 offset:50064
  global_load_dwordx4 v[168:171], v221, s[48:49] offset:-4096 sc1
  s_waitcnt lgkmcnt(13)
  v_mfma_f32_16x16x32_bf16 v[12:15], v[128:131], v[124:127], v[12:15]
  s_waitcnt lgkmcnt(12)
  v_mfma_f32_16x16x32_bf16 v[16:19], v[132:135], v[124:127], v[16:19]
  ds_read_b128 v[88:91], v53 offset:160
  ds_read_b128 v[92:95], v52 offset:33440
  ds_read_b128 v[96:99], v52 offset:50080
  global_load_dwordx4 v[172:175], v221, s[48:49] offset:0 sc1
  s_waitcnt lgkmcnt(13)
  v_mfma_f32_16x16x32_bf16 v[12:15], v[140:143], v[136:139], v[12:15]
  s_waitcnt lgkmcnt(12)
  v_mfma_f32_16x16x32_bf16 v[16:19], v[144:147], v[136:139], v[16:19]
  ds_read_b128 v[100:103], v53 offset:176
  ds_read_b128 v[104:107], v52 offset:33456
  ds_read_b128 v[108:111], v52 offset:50096
  global_load_dwordx4 v[176:179], v222, s[48:49] offset:-4096 sc1
  s_waitcnt lgkmcnt(13)
  v_mfma_f32_16x16x32_bf16 v[12:15], v[152:155], v[148:151], v[12:15]
  s_waitcnt lgkmcnt(12)
  v_mfma_f32_16x16x32_bf16 v[16:19], v[156:159], v[148:151], v[16:19]
  ds_read_b128 v[112:115], v53 offset:192
  ds_read_b128 v[116:119], v52 offset:33472
  ds_read_b128 v[120:123], v52 offset:50112
  global_load_dwordx4 v[180:183], v222, s[48:49] offset:0 sc1
  s_waitcnt lgkmcnt(13)
  v_mfma_f32_16x16x32_bf16 v[12:15], v[68:71], v[64:67], v[12:15]
  s_waitcnt lgkmcnt(12)
  v_mfma_f32_16x16x32_bf16 v[16:19], v[72:75], v[64:67], v[16:19]
  ds_read_b128 v[124:127], v53 offset:208
  ds_read_b128 v[128:131], v52 offset:33488
  ds_read_b128 v[132:135], v52 offset:50128
  global_load_dwordx4 v[184:187], v223, s[48:49] offset:-4096 sc1
  s_waitcnt lgkmcnt(13)
  v_mfma_f32_16x16x32_bf16 v[12:15], v[80:83], v[76:79], v[12:15]
  s_waitcnt lgkmcnt(12)
  v_mfma_f32_16x16x32_bf16 v[16:19], v[84:87], v[76:79], v[16:19]
  ds_read_b128 v[136:139], v53 offset:224
  ds_read_b128 v[140:143], v52 offset:33504
  ds_read_b128 v[144:147], v52 offset:50144
  global_load_dwordx4 v[188:191], v223, s[48:49] offset:0 sc1
  s_waitcnt lgkmcnt(13)
  v_mfma_f32_16x16x32_bf16 v[12:15], v[92:95], v[88:91], v[12:15]
  s_waitcnt lgkmcnt(12)
  v_mfma_f32_16x16x32_bf16 v[16:19], v[96:99], v[88:91], v[16:19]
  ds_read_b128 v[148:151], v53 offset:240
  ds_read_b128 v[152:155], v52 offset:33520
  ds_read_b128 v[156:159], v52 offset:50160
  global_load_dwordx4 v[192:195], v30, s[48:49] offset:0 sc1
  s_waitcnt lgkmcnt(13)
  v_mfma_f32_16x16x32_bf16 v[12:15], v[104:107], v[100:103], v[12:15]
  s_waitcnt lgkmcnt(12)
  v_mfma_f32_16x16x32_bf16 v[16:19], v[108:111], v[100:103], v[16:19]
  global_load_dwordx4 v[196:199], v30, s[48:49] offset:16 sc1
  s_waitcnt lgkmcnt(10)
  v_mfma_f32_16x16x32_bf16 v[12:15], v[116:119], v[112:115], v[12:15]
  s_waitcnt lgkmcnt(9)
  v_mfma_f32_16x16x32_bf16 v[16:19], v[120:123], v[112:115], v[16:19]
  global_load_dwordx4 v[200:203], v31, s[48:49] offset:0 sc1
  s_waitcnt lgkmcnt(7)
  v_mfma_f32_16x16x32_bf16 v[12:15], v[128:131], v[124:127], v[12:15]
  s_waitcnt lgkmcnt(6)
  v_mfma_f32_16x16x32_bf16 v[16:19], v[132:135], v[124:127], v[16:19]
  global_load_dwordx4 v[204:207], v31, s[48:49] offset:16 sc1
  s_waitcnt lgkmcnt(4)
  v_mfma_f32_16x16x32_bf16 v[12:15], v[140:143], v[136:139], v[12:15]
  s_waitcnt lgkmcnt(3)
  v_mfma_f32_16x16x32_bf16 v[16:19], v[144:147], v[136:139], v[16:19]
  global_load_dwordx4 v[208:211], v63, s[48:49] sc1
  s_waitcnt lgkmcnt(1)
  v_mfma_f32_16x16x32_bf16 v[12:15], v[152:155], v[148:151], v[12:15]
  s_waitcnt lgkmcnt(0)
  v_mfma_f32_16x16x32_bf16 v[16:19], v[156:159], v[148:151], v[16:19]
  s_nop 5
  v_cvt_pk_bf16_f32 v12, v12, v13
  v_cvt_pk_bf16_f32 v13, v14, v15
  v_cvt_pk_bf16_f32 v16, v16, v17
  v_cvt_pk_bf16_f32 v17, v18, v19
  ds_write_b64 v54, v[12:13]
  ds_write_b64 v54, v[16:17] offset:32
  s_waitcnt lgkmcnt(0)
  s_barrier
  s_nop 0
  ds_read_u16 v64, v40 offset:0
  ds_read_u16 v65, v41 offset:0
  ds_read_u16 v66, v42 offset:0
  ds_read_u16 v67, v43 offset:0
  ds_read_u16 v68, v44 offset:0
  ds_read_u16 v69, v45 offset:0
  ds_read_u16 v70, v46 offset:0
  ds_read_u16 v71, v47 offset:0
  ds_read_u16 v72, v48 offset:0
  ds_read_u16 v80, v40 offset:2304
  ds_read_u16 v81, v41 offset:2304
  ds_read_u16 v82, v42 offset:2304
  ds_read_u16 v83, v43 offset:2304
  ds_read_u16 v84, v44 offset:2304
  ds_read_u16 v85, v45 offset:2304
  ds_read_u16 v86, v46 offset:2304
  ds_read_u16 v87, v47 offset:2304
  ds_read_u16 v88, v48 offset:2304
  s_waitcnt lgkmcnt(14)
  v_lshl_or_b32 v100, v65, 16, v64
  v_lshl_or_b32 v101, v67, 16, v66
  s_waitcnt lgkmcnt(12)
  v_lshl_or_b32 v102, v69, 16, v68
  s_waitcnt lgkmcnt(10)
  v_lshl_or_b32 v103, v71, 16, v70
  v_lshl_or_b32 v96, v66, 16, v65
  v_lshl_or_b32 v97, v68, 16, v67
  v_lshl_or_b32 v98, v70, 16, v69
  s_waitcnt lgkmcnt(9)
  v_lshl_or_b32 v99, v72, 16, v71
  ds_write_b128 v55, v[96:99] offset:0
  ds_write_b128 v55, v[100:103] offset:4160
  s_waitcnt lgkmcnt(9)
  v_lshl_or_b32 v108, v81, 16, v80
  s_waitcnt lgkmcnt(7)
  v_lshl_or_b32 v109, v83, 16, v82
  s_waitcnt lgkmcnt(5)
  v_lshl_or_b32 v110, v85, 16, v84
  s_waitcnt lgkmcnt(3)
  v_lshl_or_b32 v111, v87, 16, v86
  v_lshl_or_b32 v104, v82, 16, v81
  v_lshl_or_b32 v105, v84, 16, v83
  v_lshl_or_b32 v106, v86, 16, v85
  s_waitcnt lgkmcnt(2)
  v_lshl_or_b32 v107, v88, 16, v87
  ds_write_b128 v55, v[104:107] offset:8320
  ds_write_b128 v55, v[108:111] offset:12480
  s_waitcnt lgkmcnt(0)
  s_barrier
  s_nop 0
  ds_read2_b32 a[0:1], v56 offset0:0 offset1:1
  ds_read2_b32 a[2:3], v56 offset0:2 offset1:3
  ds_read2_b32 a[16:17], v56 offset0:128 offset1:129
  ds_read2_b32 a[18:19], v56 offset0:130 offset1:131
  ds_read2_b32 a[32:33], v57 offset0:0 offset1:1
  ds_read2_b32 a[34:35], v57 offset0:2 offset1:3
  ds_read2_b32 a[48:49], v57 offset0:128 offset1:129
  ds_read2_b32 a[50:51], v57 offset0:130 offset1:131
  ds_read2_b32 a[64:65], v58 offset0:0 offset1:1
  ds_read2_b32 a[66:67], v58 offset0:2 offset1:3
  ds_read2_b32 a[80:81], v58 offset0:128 offset1:129
  ds_read2_b32 a[82:83], v58 offset0:130 offset1:131
  ds_read2_b32 a[96:97], v59 offset0:0 offset1:1
  ds_read2_b32 a[98:99], v59 offset0:2 offset1:3
  ds_read2_b32 a[112:113], v59 offset0:128 offset1:129
  ds_read2_b32 a[114:115], v59 offset0:130 offset1:131
  s_waitcnt vmcnt(0)
  v_xor_b32 v2, s50, v210
  v_bitop3_b32 v2, v162, s50, v2 bitop3:0xbe
  v_bitop3_b32 v2, v166, s50, v2 bitop3:0xbe
  v_bitop3_b32 v2, v170, s50, v2 bitop3:0xbe
  v_bitop3_b32 v2, v174, s50, v2 bitop3:0xbe
  v_bitop3_b32 v2, v178, s50, v2 bitop3:0xbe
  v_bitop3_b32 v2, v182, s50, v2 bitop3:0xbe
  v_bitop3_b32 v2, v186, s50, v2 bitop3:0xbe
  v_bitop3_b32 v2, v190, s50, v2 bitop3:0xbe
  v_bitop3_b32 v2, v193, s50, v2 bitop3:0xbe
  v_bitop3_b32 v2, v195, s50, v2 bitop3:0xbe
  v_bitop3_b32 v2, v197, s50, v2 bitop3:0xbe
  v_bitop3_b32 v2, v199, s50, v2 bitop3:0xbe
  v_bitop3_b32 v2, v201, s50, v2 bitop3:0xbe
  v_bitop3_b32 v2, v203, s50, v2 bitop3:0xbe
  v_bitop3_b32 v2, v205, s50, v2 bitop3:0xbe
  v_bitop3_b32 v2, v207, s50, v2 bitop3:0xbe
  v_cmp_ne_u32 vcc, 0, v2
  s_mov_b32 s8, 0
  s_cbranch_vccz L_poll0_done
L_poll0:
  s_sleep 4
  global_load_dwordx4 v[160:163], v62, s[48:49] offset:-4096 sc1
  global_load_dwordx4 v[164:167], v62, s[48:49] offset:0 sc1
  global_load_dwordx4 v[168:171], v221, s[48:49] offset:-4096 sc1
  global_load_dwordx4 v[172:175], v221, s[48:49] offset:0 sc1
  global_load_dwordx4 v[176:179], v222, s[48:49] offset:-4096 sc1
  global_load_dwordx4 v[180:183], v222, s[48:49] offset:0 sc1
  global_load_dwordx4 v[184:187], v223, s[48:49] offset:-4096 sc1
  global_load_dwordx4 v[188:191], v223, s[48:49] offset:0 sc1
  global_load_dwordx4 v[192:195], v30, s[48:49] offset:0 sc1
  global_load_dwordx4 v[196:199], v30, s[48:49] offset:16 sc1
  global_load_dwordx4 v[200:203], v31, s[48:49] offset:0 sc1
  global_load_dwordx4 v[204:207], v31, s[48:49] offset:16 sc1
  global_load_dwordx4 v[208:211], v63, s[48:49] sc1
  s_waitcnt vmcnt(0)
  v_xor_b32 v2, s50, v210
  v_bitop3_b32 v2, v162, s50, v2 bitop3:0xbe
  v_bitop3_b32 v2, v166, s50, v2 bitop3:0xbe
  v_bitop3_b32 v2, v170, s50, v2 bitop3:0xbe
  v_bitop3_b32 v2, v174, s50, v2 bitop3:0xbe
  v_bitop3_b32 v2, v178, s50, v2 bitop3:0xbe
  v_bitop3_b32 v2, v182, s50, v2 bitop3:0xbe
  v_bitop3_b32 v2, v186, s50, v2 bitop3:0xbe
  v_bitop3_b32 v2, v190, s50, v2 bitop3:0xbe
  v_bitop3_b32 v2, v193, s50, v2 bitop3:0xbe
  v_bitop3_b32 v2, v195, s50, v2 bitop3:0xbe
  v_bitop3_b32 v2, v197, s50, v2 bitop3:0xbe
  v_bitop3_b32 v2, v199, s50, v2 bitop3:0xbe
  v_bitop3_b32 v2, v201, s50, v2 bitop3:0xbe
  v_bitop3_b32 v2, v203, s50, v2 bitop3:0xbe
  v_bitop3_b32 v2, v205, s50, v2 bitop3:0xbe
  v_bitop3_b32 v2, v207, s50, v2 bitop3:0xbe
  v_cmp_ne_u32 vcc, 0, v2
  s_add_u32 s8, s8, 1
  s_cbranch_vccz L_poll0_done
  s_cmp_lt_u32 s8, 0x40000
  s_cbranch_scc1 L_poll0
L_poll0_done:
  global_load_dword v227, v225, s[36:37]
  v_add_f32_dpp v208, v208, v208 quad_perm:[1,0,3,2] row_mask:0xf bank_mask:0xf
  v_add_f32_dpp v209, v209, v209 quad_perm:[1,0,3,2] row_mask:0xf bank_mask:0xf
  v_cvt_pk_bf16_f32 v208, v208, v209
  v_lshlrev_b32 v64, 16, v192
  v_and_b32 v65, 0xffff0000, v192
  v_lshlrev_b32 v66, 16, v194
  v_and_b32 v67, 0xffff0000, v194
  v_lshlrev_b32 v68, 16, v196
  v_and_b32 v69, 0xffff0000, v196
  v_lshlrev_b32 v70, 16, v198
  v_and_b32 v71, 0xffff0000, v198
  v_readlane_b32 s11, v208, 2
  v_readlane_b32 s10, v208, 0
  v_lshlrev_b32 v72, 16, v200
  v_and_b32 v73, 0xffff0000, v200
  v_lshlrev_b32 v74, 16, v202
  v_and_b32 v75, 0xffff0000, v202
  v_lshlrev_b32 v76, 16, v204
  v_and_b32 v77, 0xffff0000, v204
  v_lshlrev_b32_e64 v78, 16, v206
  v_and_b32 v79, 0xffff0000, v206
  s_lshl_b32 s13, s11, 16
  s_and_b32 s14, s11, 0xffff0000
  v_add_f32_e64 v100, s13, 1.0
  v_add_f32_e64 v101, s14, 1.0
  s_lshl_b32 s13, s10, 16
  s_and_b32 s14, s10, 0xffff0000
  v_cvt_pk_bf16_f32 v101, v100, v101
  v_mov_b32 v102, s13
  v_mov_b32_e64 v103, s14
  v_pk_fma_f32 v[104:105], v[64:65], v[160:161], v[164:165]
  v_pk_fma_f32 v[106:107], v[66:67], v[168:169], v[172:173]
  v_pk_fma_f32 v[108:109], v[68:69], v[176:177], v[180:181]
  v_pk_fma_f32 v[110:111], v[70:71], v[184:185], v[188:189]
  v_lshlrev_b32_e64 v100, 16, v101
  v_and_b32 v101, 0xffff0000, v101
  v_pk_fma_f32 v[112:113], v[72:73], v[160:161], v[164:165]
  v_pk_fma_f32 v[114:115], v[74:75], v[168:169], v[172:173]
  v_pk_fma_f32 v[116:117], v[76:77], v[176:177], v[180:181]
  v_pk_fma_f32 v[118:119], v[78:79], v[184:185], v[188:189]
  v_pk_fma_f32 v[104:105], v[104:105], v[100:101], v[102:103] op_sel:[0,0,0] op_sel_hi:[1,0,0]
  v_pk_fma_f32 v[106:107], v[106:107], v[100:101], v[102:103] op_sel:[0,0,0] op_sel_hi:[1,0,0]
  v_pk_fma_f32 v[108:109], v[108:109], v[100:101], v[102:103] op_sel:[0,0,0] op_sel_hi:[1,0,0]
  v_pk_fma_f32 v[110:111], v[110:111], v[100:101], v[102:103] op_sel:[0,0,0] op_sel_hi:[1,0,0]
  v_cvt_pk_bf16_f32 v120, v111, v110
  v_cvt_pk_bf16_f32 v121, v109, v108
  v_cvt_pk_bf16_f32 v122, v107, v106
  v_cvt_pk_bf16_f32 v123, v105, v104
  ds_write_b128 v61, v[120:123] offset:0
  v_pk_fma_f32 v[112:113], v[112:113], v[100:101], v[102:103] op_sel:[0,1,1] op_sel_hi:[1,1,1]
  v_pk_fma_f32 v[114:115], v[114:115], v[100:101], v[102:103] op_sel:[0,1,1] op_sel_hi:[1,1,1]
  v_pk_fma_f32 v[116:117], v[116:117], v[100:101], v[102:103] op_sel:[0,1,1] op_sel_hi:[1,1,1]
  v_pk_fma_f32 v[118:119], v[118:119], v[100:101], v[102:103] op_sel:[0,1,1] op_sel_hi:[1,1,1]
  v_cvt_pk_bf16_f32 v124, v119, v118
  v_cvt_pk_bf16_f32 v125, v117, v116
  v_cvt_pk_bf16_f32 v126, v115, v114
  v_cvt_pk_bf16_f32 v127, v113, v112
  ds_write_b128 v61, v[124:127] offset:4608
  s_waitcnt lgkmcnt(0)
  s_barrier
  ds_read_b128 a[140:143], v60 offset:3584
  ds_read_b128 a[156:159], v60 offset:3072
  ds_read_b128 a[172:175], v60 offset:2560
  ds_read_b128 a[188:191], v60 offset:2048
  ds_read_b128 a[204:207], v60 offset:1536
  ds_read_b128 a[220:223], v60 offset:1024
  ds_read_b128 a[236:239], v60 offset:512
  ds_read_b128 a[252:255], v60 offset:0
  s_waitcnt lgkmcnt(7)
  s_nop 0
  v_mfma_f32_16x16x32_bf16 v[16:19], a[0:3], a[140:143], 0
  ds_read2_b32 a[4:5], v56 offset0:32 offset1:33
  v_mfma_f32_16x16x32_bf16 v[20:23], a[16:19], a[140:143], 0
  ds_read2_b32 a[6:7], v56 offset0:34 offset1:35
  v_mfma_f32_16x16x32_bf16 v[24:27], a[32:35], a[140:143], 0
  ds_read2_b32 a[20:21], v56 offset0:160 offset1:161
  v_mfma_f32_16x16x32_bf16 v[28:31], a[48:51], a[140:143], 0
  ds_read2_b32 a[22:23], v56 offset0:162 offset1:163
  v_mfma_f32_16x16x32_bf16 v[32:35], a[64:67], a[140:143], 0
  s_mul_i32 s15, s57, 24576
  s_add_u32 s15, s15, 0
  s_add_u32 m0, s15, 0
  s_mov_b32 s9, 0
  buffer_load_dwordx4 v246, s[60:63], s9 offen offset:0 lds
  v_mfma_f32_16x16x32_bf16 v[36:39], a[80:83], a[140:143], 0
  ds_read2_b32 a[36:37], v57 offset0:32 offset1:33
  v_mfma_f32_16x16x32_bf16 v[40:43], a[96:99], a[140:143], 0
  ds_read2_b32 a[38:39], v57 offset0:34 offset1:35
  v_mfma_f32_16x16x32_bf16 v[44:47], a[112:115], a[140:143], 0
  ds_read2_b32 a[52:53], v57 offset0:160 offset1:161
  s_waitcnt lgkmcnt(13)
  v_mfma_f32_16x16x32_bf16 v[20:23], a[0:3], a[156:159], v[20:23]
  ds_read2_b32 a[54:55], v57 offset0:162 offset1:163
  v_mfma_f32_16x16x32_bf16 v[24:27], a[16:19], a[156:159], v[24:27]
  buffer_load_dwordx4 v247, s[60:63], s9 offen offset:1024 lds
  v_mfma_f32_16x16x32_bf16 v[28:31], a[32:35], a[156:159], v[28:31]
  ds_read2_b32 a[68:69], v58 offset0:32 offset1:33
  v_mfma_f32_16x16x32_bf16 v[32:35], a[48:51], a[156:159], v[32:35]
  ds_read2_b32 a[70:71], v58 offset0:34 offset1:35
  v_mfma_f32_16x16x32_bf16 v[36:39], a[64:67], a[156:159], v[36:39]
  ds_read2_b32 a[84:85], v58 offset0:160 offset1:161
  v_mfma_f32_16x16x32_bf16 v[40:43], a[80:83], a[156:159], v[40:43]
  ds_read2_b32 a[86:87], v58 offset0:162 offset1:163
  v_mfma_f32_16x16x32_bf16 v[44:47], a[96:99], a[156:159], v[44:47]
  buffer_load_dwordx4 v248, s[60:63], s9 offen offset:2048 lds
  s_waitcnt lgkmcnt(14)
  s_nop 0
  v_mfma_f32_16x16x32_bf16 v[24:27], a[0:3], a[172:175], v[24:27]
  ds_read2_b32 a[100:101], v59 offset0:32 offset1:33
  v_mfma_f32_16x16x32_bf16 v[28:31], a[16:19], a[172:175], v[28:31]
  ds_read2_b32 a[102:103], v59 offset0:34 offset1:35
  v_mfma_f32_16x16x32_bf16 v[32:35], a[32:35], a[172:175], v[32:35]
  ds_read2_b32 a[116:117], v59 offset0:160 offset1:161
  v_mfma_f32_16x16x32_bf16 v[36:39], a[48:51], a[172:175], v[36:39]
  ds_read2_b32 a[118:119], v59 offset0:162 offset1:163
  v_mfma_f32_16x16x32_bf16 v[40:43], a[64:67], a[172:175], v[40:43]
  buffer_load_dwordx4 v249, s[60:63], s9 offen offset:3072 lds
  v_mfma_f32_16x16x32_bf16 v[44:47], a[80:83], a[172:175], v[44:47]
  ds_read_b128 a[136:139], v60 offset:3712
  v_mfma_f32_16x16x32_bf16 v[28:31], a[0:3], a[188:191], v[28:31]
  ds_read_b128 a[152:155], v60 offset:3200
  v_mfma_f32_16x16x32_bf16 v[32:35], a[16:19], a[188:191], v[32:35]
  ds_read_b128 a[168:171], v60 offset:2688
  v_mfma_f32_16x16x32_bf16 v[36:39], a[32:35], a[188:191], v[36:39]
  ds_read_b128 a[184:187], v60 offset:2176
  v_mfma_f32_16x16x32_bf16 v[40:43], a[48:51], a[188:191], v[40:43]
  s_add_u32 m0, s15, 4096
  s_mov_b32 s9, 114688
  buffer_load_dwordx4 v246, s[60:63], s9 offen offset:0 lds
  v_mfma_f32_16x16x32_bf16 v[44:47], a[64:67], a[188:191], v[44:47]
  ds_read_b128 a[200:203], v60 offset:1664
  v_mfma_f32_16x16x32_bf16 v[32:35], a[0:3], a[204:207], v[32:35]
  ds_read_b128 a[216:219], v60 offset:1152
  v_mfma_f32_16x16x32_bf16 v[36:39], a[16:19], a[204:207], v[36:39]
  ds_read_b128 a[232:235], v60 offset:640
  v_mfma_f32_16x16x32_bf16 v[40:43], a[32:35], a[204:207], v[40:43]
  ds_read_b128 a[248:251], v60 offset:128
  v_mfma_f32_16x16x32_bf16 v[44:47], a[48:51], a[204:207], v[44:47]
  buffer_load_dwordx4 v247, s[60:63], s9 offen offset:1024 lds
  v_mfma_f32_16x16x32_bf16 v[36:39], a[0:3], a[220:223], v[36:39]
  s_lshl_b32 s13, s59, 16
  s_and_b32 s14, s59, 0xffff0000
  v_mfma_f32_16x16x32_bf16 v[40:43], a[16:19], a[220:223], v[40:43]
  s_mul_i32 s6, s57, 10240
  s_add_u32 s6, s6, 110240
  v_mfma_f32_16x16x32_bf16 v[44:47], a[32:35], a[220:223], v[44:47]
  v_mul_u32_u24 v4, 80, v49
  v_lshl_add_u32 v4, v50, 4, v4
  s_waitcnt lgkmcnt(14)
  v_mfma_f32_16x16x32_bf16 v[40:43], a[0:3], a[236:239], v[40:43]
  v_add_u32 v4, s6, v4
  v_lshlrev_b32 v14, 16, v120
  v_mfma_f32_16x16x32_bf16 v[44:47], a[16:19], a[236:239], v[44:47]
  buffer_load_dwordx4 v248, s[60:63], s9 offen offset:2048 lds
  v_mfma_f32_16x16x32_bf16 v[44:47], a[0:3], a[252:255], v[44:47]
  v_and_b32 v15, 0xffff0000, v120
  v_mul_f32 v135, s13, v14
  s_waitcnt lgkmcnt(0)
  v_mfma_f32_16x16x32_bf16 v[16:19], a[4:7], a[136:139], v[16:19]
  ds_read2_b32 a[8:9], v56 offset0:64 offset1:65
  v_mfma_f32_16x16x32_bf16 v[20:23], a[20:23], a[136:139], v[20:23]
  ds_read2_b32 a[10:11], v56 offset0:66 offset1:67
  v_mfma_f32_16x16x32_bf16 v[24:27], a[36:39], a[136:139], v[24:27]
  ds_read2_b32 a[24:25], v56 offset0:192 offset1:193
  v_mfma_f32_16x16x32_bf16 v[28:31], a[52:55], a[136:139], v[28:31]
  buffer_load_dwordx4 v249, s[60:63], s9 offen offset:3072 lds
  v_mfma_f32_16x16x32_bf16 v[32:35], a[68:71], a[136:139], v[32:35]
  ds_read2_b32 a[26:27], v56 offset0:194 offset1:195
  v_mfma_f32_16x16x32_bf16 v[36:39], a[84:87], a[136:139], v[36:39]
  ds_read2_b32 a[40:41], v57 offset0:64 offset1:65
  v_mfma_f32_16x16x32_bf16 v[40:43], a[100:103], a[136:139], v[40:43]
  ds_read2_b32 a[42:43], v57 offset0:66 offset1:67
  v_mfma_f32_16x16x32_bf16 v[44:47], a[116:119], a[136:139], v[44:47]
  ds_read2_b32 a[56:57], v57 offset0:192 offset1:193
  v_mfma_f32_16x16x32_bf16 v[20:23], a[4:7], a[152:155], v[20:23]
  s_add_u32 m0, s15, 8192
  s_mov_b32 s9, 229376
  buffer_load_dwordx4 v246, s[60:63], s9 offen offset:0 lds
  v_mfma_f32_16x16x32_bf16 v[24:27], a[20:23], a[152:155], v[24:27]
  ds_read2_b32 a[58:59], v57 offset0:194 offset1:195
  v_mfma_f32_16x16x32_bf16 v[28:31], a[36:39], a[152:155], v[28:31]
  ds_read2_b32 a[72:73], v58 offset0:64 offset1:65
  v_mfma_f32_16x16x32_bf16 v[32:35], a[52:55], a[152:155], v[32:35]
  ds_read2_b32 a[74:75], v58 offset0:66 offset1:67
  v_mfma_f32_16x16x32_bf16 v[36:39], a[68:71], a[152:155], v[36:39]
  ds_read2_b32 a[88:89], v58 offset0:192 offset1:193
  v_mfma_f32_16x16x32_bf16 v[40:43], a[84:87], a[152:155], v[40:43]
  buffer_load_dwordx4 v247, s[60:63], s9 offen offset:1024 lds
  v_mfma_f32_16x16x32_bf16 v[44:47], a[100:103], a[152:155], v[44:47]
  ds_read2_b32 a[90:91], v58 offset0:194 offset1:195
  v_mfma_f32_16x16x32_bf16 v[24:27], a[4:7], a[168:171], v[24:27]
  ds_read2_b32 a[104:105], v59 offset0:64 offset1:65
  v_mfma_f32_16x16x32_bf16 v[28:31], a[20:23], a[168:171], v[28:31]
  ds_read2_b32 a[106:107], v59 offset0:66 offset1:67
  v_mfma_f32_16x16x32_bf16 v[32:35], a[36:39], a[168:171], v[32:35]
  ds_read2_b32 a[120:121], v59 offset0:192 offset1:193
  v_mfma_f32_16x16x32_bf16 v[36:39], a[52:55], a[168:171], v[36:39]
  buffer_load_dwordx4 v248, s[60:63], s9 offen offset:2048 lds
  v_mfma_f32_16x16x32_bf16 v[40:43], a[68:71], a[168:171], v[40:43]
  ds_read2_b32 a[122:123], v59 offset0:194 offset1:195
  v_mfma_f32_16x16x32_bf16 v[44:47], a[84:87], a[168:171], v[44:47]
  ds_read_b128 a[132:135], v60 offset:3840
  v_mfma_f32_16x16x32_bf16 v[28:31], a[4:7], a[184:187], v[28:31]
  ds_read_b128 a[148:151], v60 offset:3328
  v_mfma_f32_16x16x32_bf16 v[32:35], a[20:23], a[184:187], v[32:35]
  ds_read_b128 a[164:167], v60 offset:2816
  v_mfma_f32_16x16x32_bf16 v[36:39], a[36:39], a[184:187], v[36:39]
  buffer_load_dwordx4 v249, s[60:63], s9 offen offset:3072 lds
  v_mfma_f32_16x16x32_bf16 v[40:43], a[52:55], a[184:187], v[40:43]
  ds_read_b128 a[180:183], v60 offset:2304
  v_mfma_f32_16x16x32_bf16 v[44:47], a[68:71], a[184:187], v[44:47]
  ds_read_b128 a[196:199], v60 offset:1792
  v_mfma_f32_16x16x32_bf16 v[32:35], a[4:7], a[200:203], v[32:35]
  ds_read_b128 a[212:215], v60 offset:1280
  v_mfma_f32_16x16x32_bf16 v[36:39], a[20:23], a[200:203], v[36:39]
  ds_read_b128 a[228:231], v60 offset:768
  v_mfma_f32_16x16x32_bf16 v[40:43], a[36:39], a[200:203], v[40:43]
  s_add_u32 m0, s15, 12288
  s_mov_b32 s9, 344064
  buffer_load_dwordx4 v246, s[60:63], s9 offen offset:0 lds
  v_mfma_f32_16x16x32_bf16 v[44:47], a[52:55], a[200:203], v[44:47]
  ds_read_b128 a[244:247], v60 offset:256
  v_mfma_f32_16x16x32_bf16 v[36:39], a[4:7], a[216:219], v[36:39]
  v_mul_f32 v134, s13, v15
  v_lshlrev_b32 v14, 16, v121
  v_mfma_f32_16x16x32_bf16 v[40:43], a[20:23], a[216:219], v[40:43]
  v_and_b32 v15, 0xffff0000, v121
  v_mul_f32 v133, s13, v14
  v_mfma_f32_16x16x32_bf16 v[44:47], a[36:39], a[216:219], v[44:47]
  v_mul_f32 v132, s13, v15
  v_lshlrev_b32_e64 v14, 16, v122
  v_mfma_f32_16x16x32_bf16 v[40:43], a[4:7], a[232:235], v[40:43]
  buffer_load_dwordx4 v247, s[60:63], s9 offen offset:1024 lds
  v_mfma_f32_16x16x32_bf16 v[44:47], a[20:23], a[232:235], v[44:47]
  v_and_b32 v15, 0xffff0000, v122
  v_mul_f32 v131, s13, v14
  v_mfma_f32_16x16x32_bf16 v[44:47], a[4:7], a[248:251], v[44:47]
  v_mul_f32 v130, s13, v15
  v_lshlrev_b32 v14, 16, v123
  s_waitcnt lgkmcnt(0)
  v_mfma_f32_16x16x32_bf16 v[16:19], a[8:11], a[132:135], v[16:19]
  ds_read2_b32 a[12:13], v56 offset0:96 offset1:97
  v_mfma_f32_16x16x32_bf16 v[20:23], a[24:27], a[132:135], v[20:23]
  ds_read2_b32 a[14:15], v56 offset0:98 offset1:99
  v_mfma_f32_16x16x32_bf16 v[24:27], a[40:43], a[132:135], v[24:27]
  buffer_load_dwordx4 v248, s[60:63], s9 offen offset:2048 lds
  v_mfma_f32_16x16x32_bf16 v[28:31], a[56:59], a[132:135], v[28:31]
  ds_read2_b32 a[28:29], v56 offset0:224 offset1:225
  v_mfma_f32_16x16x32_bf16 v[32:35], a[72:75], a[132:135], v[32:35]
  ds_read2_b32 a[30:31], v56 offset0:226 offset1:227
  v_mfma_f32_16x16x32_bf16 v[36:39], a[88:91], a[132:135], v[36:39]
  ds_read2_b32 a[44:45], v57 offset0:96 offset1:97
  v_mfma_f32_16x16x32_bf16 v[40:43], a[104:107], a[132:135], v[40:43]
  ds_read2_b32 a[46:47], v57 offset0:98 offset1:99
  v_mfma_f32_16x16x32_bf16 v[44:47], a[120:123], a[132:135], v[44:47]
  buffer_load_dwordx4 v249, s[60:63], s9 offen offset:3072 lds
  v_mfma_f32_16x16x32_bf16 v[20:23], a[8:11], a[148:151], v[20:23]
  ds_read2_b32 a[60:61], v57 offset0:224 offset1:225
  v_mfma_f32_16x16x32_bf16 v[24:27], a[24:27], a[148:151], v[24:27]
  ds_read2_b32 a[62:63], v57 offset0:226 offset1:227
  v_mfma_f32_16x16x32_bf16 v[28:31], a[40:43], a[148:151], v[28:31]
  ds_read2_b32 a[76:77], v58 offset0:96 offset1:97
  v_mfma_f32_16x16x32_bf16 v[32:35], a[56:59], a[148:151], v[32:35]
  ds_read2_b32 a[78:79], v58 offset0:98 offset1:99
  v_mfma_f32_16x16x32_bf16 v[36:39], a[72:75], a[148:151], v[36:39]
  s_add_u32 m0, s15, 16384
  s_mov_b32 s9, 458752
  buffer_load_dwordx4 v246, s[60:63], s9 offen offset:0 lds
  v_mfma_f32_16x16x32_bf16 v[40:43], a[88:91], a[148:151], v[40:43]
  ds_read2_b32 a[92:93], v58 offset0:224 offset1:225
  v_mfma_f32_16x16x32_bf16 v[44:47], a[104:107], a[148:151], v[44:47]
  ds_read2_b32 a[94:95], v58 offset0:226 offset1:227
  v_mfma_f32_16x16x32_bf16 v[24:27], a[8:11], a[164:167], v[24:27]
  ds_read2_b32 a[108:109], v59 offset0:96 offset1:97
  v_mfma_f32_16x16x32_bf16 v[28:31], a[24:27], a[164:167], v[28:31]
  ds_read2_b32 a[110:111], v59 offset0:98 offset1:99
  v_mfma_f32_16x16x32_bf16 v[32:35], a[40:43], a[164:167], v[32:35]
  buffer_load_dwordx4 v247, s[60:63], s9 offen offset:1024 lds
  v_mfma_f32_16x16x32_bf16 v[36:39], a[56:59], a[164:167], v[36:39]
  ds_read2_b32 a[124:125], v59 offset0:224 offset1:225
  v_mfma_f32_16x16x32_bf16 v[40:43], a[72:75], a[164:167], v[40:43]
  ds_read2_b32 a[126:127], v59 offset0:226 offset1:227
  v_mfma_f32_16x16x32_bf16 v[44:47], a[88:91], a[164:167], v[44:47]
  ds_read_b128 a[128:131], v60 offset:3968
  v_mfma_f32_16x16x32_bf16 v[28:31], a[8:11], a[180:183], v[28:31]
  ds_read_b128 a[144:147], v60 offset:3456
  v_mfma_f32_16x16x32_bf16 v[32:35], a[24:27], a[180:183], v[32:35]
  buffer_load_dwordx4 v248, s[60:63], s9 offen offset:2048 lds
  v_mfma_f32_16x16x32_bf16 v[36:39], a[40:43], a[180:183], v[36:39]
  ds_read_b128 a[160:163], v60 offset:2944
  v_mfma_f32_16x16x32_bf16 v[40:43], a[56:59], a[180:183], v[40:43]
  ds_read_b128 a[176:179], v60 offset:2432
  v_mfma_f32_16x16x32_bf16 v[44:47], a[72:75], a[180:183], v[44:47]
  ds_read_b128 a[192:195], v60 offset:1920
  v_mfma_f32_16x16x32_bf16 v[32:35], a[8:11], a[196:199], v[32:35]
  ds_read_b128 a[208:211], v60 offset:1408
  v_mfma_f32_16x16x32_bf16 v[36:39], a[24:27], a[196:199], v[36:39]
  buffer_load_dwordx4 v249, s[60:63], s9 offen offset:3072 lds
  v_mfma_f32_16x16x32_bf16 v[40:43], a[40:43], a[196:199], v[40:43]
  ds_read_b128 a[224:227], v60 offset:896
  v_mfma_f32_16x16x32_bf16 v[44:47], a[56:59], a[196:199], v[44:47]
  ds_read_b128 a[240:243], v60 offset:384
  v_mfma_f32_16x16x32_bf16 v[36:39], a[8:11], a[212:215], v[36:39]
  v_and_b32 v15, 0xffff0000, v123
  v_mul_f32 v129, s13, v14
  v_mfma_f32_16x16x32_bf16 v[40:43], a[24:27], a[212:215], v[40:43]
  v_mul_f32 v128, s13, v15
  v_lshlrev_b32_e64 v14, 16, v124
  v_mfma_f32_16x16x32_bf16 v[44:47], a[40:43], a[212:215], v[44:47]
  s_add_u32 m0, s15, 20480
  s_mov_b32 s9, 573440
  buffer_load_dwordx4 v246, s[60:63], s9 offen offset:0 lds
  v_mfma_f32_16x16x32_bf16 v[40:43], a[8:11], a[228:231], v[40:43]
  v_and_b32 v15, 0xffff0000, v124
  v_mul_f32 v143, s14, v14
  v_mfma_f32_16x16x32_bf16 v[44:47], a[24:27], a[228:231], v[44:47]
  v_mul_f32 v142, s14, v15
  v_lshlrev_b32 v14, 16, v125
  v_mfma_f32_16x16x32_bf16 v[44:47], a[8:11], a[244:247], v[44:47]
  v_and_b32 v15, 0xffff0000, v125
  v_mul_f32 v141, s14, v14
  s_waitcnt lgkmcnt(0)
  s_barrier
  v_mfma_f32_16x16x32_bf16 v[16:19], a[12:15], a[128:131], v[16:19]
  v_mul_f32 v140, s14, v15
  v_lshlrev_b32 v14, 16, v126
  v_mfma_f32_16x16x32_bf16 v[20:23], a[28:31], a[128:131], v[20:23]
  buffer_load_dwordx4 v247, s[60:63], s9 offen offset:1024 lds
  v_mfma_f32_16x16x32_bf16 v[24:27], a[44:47], a[128:131], v[24:27]
  v_and_b32 v15, 0xffff0000, v126
  v_mul_f32 v139, s14, v14
  v_mfma_f32_16x16x32_bf16 v[28:31], a[60:63], a[128:131], v[28:31]
  v_mul_f32 v138, s14, v15
  v_lshlrev_b32 v14, 16, v127
  v_mfma_f32_16x16x32_bf16 v[32:35], a[76:79], a[128:131], v[32:35]
  v_and_b32 v15, 0xffff0000, v127
  v_mul_f32 v137, s14, v14
  v_mfma_f32_16x16x32_bf16 v[36:39], a[92:95], a[128:131], v[36:39]
  v_mul_f32 v136, s14, v15
  v_lshrrev_b32 v2, 1, v0
  v_mfma_f32_16x16x32_bf16 v[40:43], a[108:111], a[128:131], v[40:43]
  ds_write_b128 v4, v[16:19] offset:0
  v_mfma_f32_16x16x32_bf16 v[44:47], a[124:127], a[128:131], v[44:47]
  v_mul_u32_u24 v2, 80, v2
  v_and_b32_e64 v14, 1, v0
  v_mfma_f32_16x16x32_bf16 v[20:23], a[12:15], a[144:147], v[20:23]
  v_lshl_add_u32 v2, v14, 5, v2
  v_add_u32 v2, 110240, v2
  v_mfma_f32_16x16x32_bf16 v[24:27], a[28:31], a[144:147], v[24:27]
  s_mul_i32 s6, s54, 8448
  s_add_u32 s6, s6, 262144
  v_mfma_f32_16x16x32_bf16 v[28:31], a[44:47], a[144:147], v[28:31]
  v_lshl_add_u32 v8, v0, 4, s6
  v_add_u32 v9, 4224, v8
  v_mfma_f32_16x16x32_bf16 v[32:35], a[60:63], a[144:147], v[32:35]
  buffer_load_dwordx4 v248, s[60:63], s9 offen offset:2048 lds
  v_mfma_f32_16x16x32_bf16 v[36:39], a[76:79], a[144:147], v[36:39]
  v_min_u32 v144, 223, v0
  v_lshlrev_b32 v145, 3, v144
  v_mfma_f32_16x16x32_bf16 v[40:43], a[92:95], a[144:147], v[40:43]
  v_add_u32 v145, 25856, v145
  v_and_b32 v146, 31, v1
  v_mfma_f32_16x16x32_bf16 v[44:47], a[108:111], a[144:147], v[44:47]
  ds_write_b128 v4, v[20:23] offset:1280
  v_mfma_f32_16x16x32_bf16 v[24:27], a[12:15], a[160:163], v[24:27]
  s_lshl_b32 s6, s56, 8
  s_add_u32 s6, s6, 29440
  v_mfma_f32_16x16x32_bf16 v[28:31], a[28:31], a[160:163], v[28:31]
  buffer_load_dwordx4 v249, s[60:63], s9 offen offset:3072 lds
  v_mfma_f32_16x16x32_bf16 v[32:35], a[44:47], a[160:163], v[32:35]
  v_lshl_add_u32 v147, v146, 3, s6
  s_mul_i32 s6, s57, 224
  v_mfma_f32_16x16x32_bf16 v[36:39], a[60:63], a[160:163], v[36:39]
  s_add_u32 s6, s6, s54
  s_lshl_b32 s6, s6, 6
  v_mfma_f32_16x16x32_bf16 v[40:43], a[76:79], a[160:163], v[40:43]
  s_add_u32 s6, s6, 65536
  v_mov_b32 v157, s6
  v_mfma_f32_16x16x32_bf16 v[44:47], a[92:95], a[160:163], v[44:47]
  v_mov_b32 v239, s50
  s_lshl_b32 s6, s54, 3
  v_mfma_f32_16x16x32_bf16 v[28:31], a[12:15], a[176:179], v[28:31]
  ds_write_b128 v4, v[24:27] offset:2560
  v_mfma_f32_16x16x32_bf16 v[32:35], a[28:31], a[176:179], v[32:35]
  s_add_u32 s6, s6, 24064
  v_mov_b32_e64 v156, s6
  v_mfma_f32_16x16x32_bf16 v[36:39], a[44:47], a[176:179], v[36:39]
  global_load_dwordx2 v[148:149], v145, s[48:49] sc1
  global_load_dwordx2 v[150:151], v145, s[48:49] offset:1792 sc1
  v_mfma_f32_16x16x32_bf16 v[40:43], a[60:63], a[176:179], v[40:43]
  global_load_dwordx2 v[152:153], v147, s[48:49] sc1
  global_load_dwordx2 v[154:155], v156, s[48:49] sc1
  v_mfma_f32_16x16x32_bf16 v[44:47], a[76:79], a[176:179], v[44:47]
  v_mfma_f32_16x16x32_bf16 v[32:35], a[12:15], a[192:195], v[32:35]
  v_mfma_f32_16x16x32_bf16 v[36:39], a[28:31], a[192:195], v[36:39]
  ds_write_b128 v4, v[28:31] offset:3840
  v_mfma_f32_16x16x32_bf16 v[40:43], a[44:47], a[192:195], v[40:43]
  v_mfma_f32_16x16x32_bf16 v[44:47], a[60:63], a[192:195], v[44:47]
  v_mfma_f32_16x16x32_bf16 v[36:39], a[12:15], a[208:211], v[36:39]
  v_mfma_f32_16x16x32_bf16 v[40:43], a[28:31], a[208:211], v[40:43]
  v_mfma_f32_16x16x32_bf16 v[44:47], a[44:47], a[208:211], v[44:47]
  s_nop 0
  ds_write_b128 v4, v[32:35] offset:5120
  v_mfma_f32_16x16x32_bf16 v[40:43], a[12:15], a[224:227], v[40:43]
  v_mfma_f32_16x16x32_bf16 v[44:47], a[28:31], a[224:227], v[44:47]
  v_mfma_f32_16x16x32_bf16 v[44:47], a[12:15], a[240:243], v[44:47]
  s_nop 0
  ds_write_b128 v4, v[36:39] offset:6400
  s_nop 3
  ds_write_b128 v4, v[40:43] offset:7680
  s_nop 0
  ds_write_b128 v4, v[44:47] offset:8960
  s_waitcnt lgkmcnt(0)
  s_barrier
  ds_read_b128 v[160:163], v2 offset:0
  ds_read_b128 v[164:167], v2 offset:16
  ds_read_b128 v[168:171], v2 offset:10240
  ds_read_b128 v[172:175], v2 offset:10256
  ds_read_b128 v[176:179], v2 offset:20480
  ds_read_b128 v[180:183], v2 offset:20496
  ds_read_b128 v[184:187], v2 offset:30720
  ds_read_b128 v[188:191], v2 offset:30736
  s_waitcnt vmcnt(3)
  v_xor_b32_e64 v14, s50, v149
  s_waitcnt vmcnt(2)
  v_bitop3_b32 v14, v151, s50, v14 bitop3:0xbe
  s_waitcnt vmcnt(1)
  v_bitop3_b32 v14, v153, s50, v14 bitop3:0xbe
  s_waitcnt vmcnt(0)
  v_bitop3_b32 v14, v155, s50, v14 bitop3:0xbe
  v_cmp_ne_u32 vcc, 0, v14
  s_mov_b32 s8, 0
  s_cbranch_vccz L_pollm_done
L_pollm:
  s_sleep 4
  global_load_dwordx2 v[148:149], v145, s[48:49] sc1
  global_load_dwordx2 v[150:151], v145, s[48:49] offset:1792 sc1
  global_load_dwordx2 v[152:153], v147, s[48:49] sc1
  global_load_dwordx2 v[154:155], v156, s[48:49] sc1
  s_waitcnt vmcnt(3)
  v_xor_b32 v14, s50, v149
  s_waitcnt vmcnt(2)
  v_bitop3_b32 v14, v151, s50, v14 bitop3:0xbe
  s_waitcnt vmcnt(1)
  v_bitop3_b32 v14, v153, s50, v14 bitop3:0xbe
  s_waitcnt vmcnt(0)
  v_bitop3_b32 v14, v155, s50, v14 bitop3:0xbe
  v_cmp_ne_u32 vcc, 0, v14
  s_add_u32 s8, s8, 1
  s_cbranch_vccz L_pollm_done
  s_cmp_lt_u32 s8, 0x40000
  s_cbranch_scc1 L_pollm
L_pollm_done:
  v_lshlrev_b32 v10, 16, v154
  v_and_b32 v11, 0xffff0000, v154
  s_waitcnt lgkmcnt(7)
  v_pk_add_f32 v[160:161], v[160:161], v[128:129]
  v_pk_add_f32 v[162:163], v[162:163], v[130:131]
  s_waitcnt lgkmcnt(6)
  v_pk_add_f32 v[164:165], v[164:165], v[132:133]
  v_pk_add_f32 v[166:167], v[166:167], v[134:135]
  s_waitcnt lgkmcnt(5)
  v_pk_add_f32 v[160:161], v[160:161], v[168:169]
  v_pk_add_f32 v[162:163], v[162:163], v[170:171]
  s_waitcnt lgkmcnt(4)
  v_pk_add_f32 v[164:165], v[164:165], v[172:173]
  v_pk_add_f32 v[166:167], v[166:167], v[174:175]
  v_pk_fma_f32 v[160:161], v[160:161], v[10:11], v[64:65] op_sel:[0,0,0] op_sel_hi:[1,0,1]
  v_pk_fma_f32 v[162:163], v[162:163], v[10:11], v[66:67] op_sel:[0,0,0] op_sel_hi:[1,0,1]
  v_pk_fma_f32 v[164:165], v[164:165], v[10:11], v[68:69] op_sel:[0,0,0] op_sel_hi:[1,0,1]
  v_pk_fma_f32 v[166:167], v[166:167], v[10:11], v[70:71] op_sel:[0,0,0] op_sel_hi:[1,0,1]
  v_cvt_pk_bf16_f32 v96, v160, v161
  v_cvt_pk_bf16_f32 v97, v162, v163
  v_cvt_pk_bf16_f32 v98, v164, v165
  v_cvt_pk_bf16_f32 v99, v166, v167
  global_store_dwordx4 v8, v[96:99], s[48:49] sc1
  s_waitcnt lgkmcnt(3)
  v_pk_add_f32 v[176:177], v[176:177], v[136:137]
  v_pk_add_f32 v[178:179], v[178:179], v[138:139]
  s_waitcnt lgkmcnt(2)
  v_pk_add_f32 v[180:181], v[180:181], v[140:141]
  v_pk_add_f32 v[182:183], v[182:183], v[142:143]
  s_waitcnt lgkmcnt(1)
  v_pk_add_f32 v[176:177], v[176:177], v[184:185]
  v_pk_add_f32 v[178:179], v[178:179], v[186:187]
  s_waitcnt lgkmcnt(0)
  v_pk_add_f32 v[180:181], v[180:181], v[188:189]
  v_pk_add_f32 v[182:183], v[182:183], v[190:191]
  v_pk_fma_f32 v[176:177], v[176:177], v[10:11], v[72:73] op_sel:[0,1,0] op_sel_hi:[1,1,1]
  v_pk_fma_f32 v[178:179], v[178:179], v[10:11], v[74:75] op_sel:[0,1,0] op_sel_hi:[1,1,1]
  v_pk_fma_f32 v[180:181], v[180:181], v[10:11], v[76:77] op_sel:[0,1,0] op_sel_hi:[1,1,1]
  v_pk_fma_f32 v[182:183], v[182:183], v[10:11], v[78:79] op_sel:[0,1,0] op_sel_hi:[1,1,1]
  v_cvt_pk_bf16_f32 v100, v176, v177
  v_cvt_pk_bf16_f32 v101, v178, v179
  v_cvt_pk_bf16_f32 v102, v180, v181
  v_cvt_pk_bf16_f32 v103, v182, v183
  global_store_dwordx4 v9, v[100:103], s[48:49] sc1
  ds_read_b64_tr_b16 a[0:1], v242 offset:0
  ds_read_b64_tr_b16 a[2:3], v242 offset:1024
  ds_read_b64_tr_b16 a[112:113], v243 offset:0
  ds_read_b64_tr_b16 a[114:115], v243 offset:1024
  ds_read_b64_tr_b16 a[4:5], v242 offset:2048
  ds_read_b64_tr_b16 a[6:7], v242 offset:3072
  ds_read_b64_tr_b16 a[116:117], v243 offset:2048
  ds_read_b64_tr_b16 a[118:119], v243 offset:3072
  ds_read_b64_tr_b16 a[8:9], v242 offset:4096
  ds_read_b64_tr_b16 a[10:11], v242 offset:5120
  ds_read_b64_tr_b16 a[120:121], v243 offset:4096
  ds_read_b64_tr_b16 a[122:123], v243 offset:5120
  ds_read_b64_tr_b16 a[12:13], v242 offset:6144
  ds_read_b64_tr_b16 a[14:15], v242 offset:7168
  ds_read_b64_tr_b16 a[124:125], v243 offset:6144
  ds_read_b64_tr_b16 a[126:127], v243 offset:7168
  ds_read_b64_tr_b16 a[16:17], v242 offset:8192
  ds_read_b64_tr_b16 a[18:19], v242 offset:9216
  ds_read_b64_tr_b16 a[128:129], v243 offset:8192
  ds_read_b64_tr_b16 a[130:131], v243 offset:9216
  ds_read_b64_tr_b16 a[20:21], v242 offset:10240
  ds_read_b64_tr_b16 a[22:23], v242 offset:11264
  ds_read_b64_tr_b16 a[132:133], v243 offset:10240
  ds_read_b64_tr_b16 a[134:135], v243 offset:11264
  ds_read_b64_tr_b16 a[24:25], v242 offset:12288
  ds_read_b64_tr_b16 a[26:27], v242 offset:13312
  ds_read_b64_tr_b16 a[136:137], v243 offset:12288
  ds_read_b64_tr_b16 a[138:139], v243 offset:13312
  ds_read_b64_tr_b16 a[28:29], v242 offset:14336
  ds_read_b64_tr_b16 a[30:31], v242 offset:15360
  ds_read_b64_tr_b16 a[140:141], v243 offset:14336
  ds_read_b64_tr_b16 a[142:143], v243 offset:15360
  ds_read_b64_tr_b16 a[32:33], v242 offset:16384
  ds_read_b64_tr_b16 a[34:35], v242 offset:17408
  ds_read_b64_tr_b16 a[144:145], v243 offset:16384
  ds_read_b64_tr_b16 a[146:147], v243 offset:17408
  ds_read_b64_tr_b16 a[36:37], v242 offset:18432
  ds_read_b64_tr_b16 a[38:39], v242 offset:19456
  ds_read_b64_tr_b16 a[148:149], v243 offset:18432
  ds_read_b64_tr_b16 a[150:151], v243 offset:19456
  ds_read_b64_tr_b16 a[40:41], v242 offset:20480
  ds_read_b64_tr_b16 a[42:43], v242 offset:21504
  ds_read_b64_tr_b16 a[152:153], v243 offset:20480
  ds_read_b64_tr_b16 a[154:155], v243 offset:21504
  ds_read_b64_tr_b16 a[44:45], v242 offset:22528
  ds_read_b64_tr_b16 a[46:47], v242 offset:23552
  ds_read_b64_tr_b16 a[156:157], v243 offset:22528
  ds_read_b64_tr_b16 a[158:159], v243 offset:23552
  v_lshlrev_b32 v14, 16, v150
  v_and_b32 v15, 0xffff0000, v150
  v_pk_add_f32 v[14:15], v[14:15], 1.0 op_sel_hi:[1,0]
  v_lshlrev_b32 v17, 16, v148
  v_and_b32 v19, 0xffff0000, v148
  v_cvt_pk_bf16_f32 v150, v14, v15
  v_lshlrev_b32 v144, 4, v144
  v_add_u32 v144, 98304, v144
  v_lshlrev_b32 v16, 16, v150
  v_and_b32 v18, 0xffff0000, v150
  v_lshlrev_b32 v14, 16, v152
  v_and_b32 v15, 0xffff0000, v152
  v_lshlrev_b32 v146, 3, v146
  v_add_u32 v146, 103936, v146
  s_mov_b32 s6, 0x3fb8aa3b
  s_mov_b32 s7, 0x3f317218
  v_pk_mul_f32 v[16:17], v[16:17], s[6:7] op_sel_hi:[1,0]
  v_pk_mul_f32 v[18:19], v[18:19], s[6:7] op_sel_hi:[1,0]
  v_pk_mul_f32 v[14:15], v[14:15], s[6:7] op_sel:[0,1] op_sel_hi:[1,1]
  s_waitcnt lgkmcnt(0)
  s_mul_i32 s15, s57, 24576
  s_add_u32 s15, s15, 0
  s_add_u32 m0, s15, 0
  s_nop 0
  s_mov_b32 s9, 688128
  buffer_load_dwordx4 v246, s[60:63], s9 offen offset:0 lds
  buffer_load_dwordx4 v247, s[60:63], s9 offen offset:1024 lds
  buffer_load_dwordx4 v248, s[60:63], s9 offen offset:2048 lds
  buffer_load_dwordx4 v249, s[60:63], s9 offen offset:3072 lds
  s_add_u32 m0, s15, 4096
  s_mov_b32 s9, 802816
  buffer_load_dwordx4 v246, s[60:63], s9 offen offset:0 lds
  buffer_load_dwordx4 v247, s[60:63], s9 offen offset:1024 lds
  buffer_load_dwordx4 v248, s[60:63], s9 offen offset:2048 lds
  buffer_load_dwordx4 v249, s[60:63], s9 offen offset:3072 lds
  s_waitcnt vmcnt(8)
  s_mov_b64 exec, 1
  global_store_dword v157, v239, s[48:49] sc1
  s_mov_b64 exec, -1
  ds_write_b128 v144, v[16:19]
  ds_write_b64 v146, v[14:15]
  s_waitcnt lgkmcnt(0)
  s_barrier
  s_nop 0
  s_add_u32 m0, s15, 8192
  s_mov_b32 s9, 917504
  buffer_load_dwordx4 v246, s[60:63], s9 offen offset:0 lds
  buffer_load_dwordx4 v247, s[60:63], s9 offen offset:1024 lds
  buffer_load_dwordx4 v248, s[60:63], s9 offen offset:2048 lds
  buffer_load_dwordx4 v249, s[60:63], s9 offen offset:3072 lds
  s_add_u32 m0, s15, 12288
  s_mov_b32 s9, 1032192
  buffer_load_dwordx4 v246, s[60:63], s9 offen offset:0 lds
  buffer_load_dwordx4 v247, s[60:63], s9 offen offset:1024 lds
  buffer_load_dwordx4 v248, s[60:63], s9 offen offset:2048 lds
  buffer_load_dwordx4 v249, s[60:63], s9 offen offset:3072 lds
  s_add_u32 m0, s15, 16384
  s_mov_b32 s9, 1146880
  buffer_load_dwordx4 v246, s[60:63], s9 offen offset:0 lds
  buffer_load_dwordx4 v247, s[60:63], s9 offen offset:1024 lds
  buffer_load_dwordx4 v248, s[60:63], s9 offen offset:2048 lds
  buffer_load_dwordx4 v249, s[60:63], s9 offen offset:3072 lds
  s_add_u32 m0, s15, 20480
  s_mov_b32 s9, 1261568
  buffer_load_dwordx4 v246, s[60:63], s9 offen offset:0 lds
  buffer_load_dwordx4 v247, s[60:63], s9 offen offset:1024 lds
  buffer_load_dwordx4 v248, s[60:63], s9 offen offset:2048 lds
  buffer_load_dwordx4 v249, s[60:63], s9 offen offset:3072 lds
  s_mul_i32 s15, s57, 8192
  s_add_u32 s15, s15, 106496
  s_add_u32 m0, s15, 0
  s_nop 0
  s_mov_b32 s9, 1376256
  buffer_load_dwordx4 v246, s[60:63], s9 offen offset:0 lds
  buffer_load_dwordx4 v247, s[60:63], s9 offen offset:1024 lds
  buffer_load_dwordx4 v248, s[60:63], s9 offen offset:2048 lds
  buffer_load_dwordx4 v249, s[60:63], s9 offen offset:3072 lds
  s_add_u32 m0, s15, 4096
  s_mov_b32 s9, 1490944
  buffer_load_dwordx4 v246, s[60:63], s9 offen offset:0 lds
  buffer_load_dwordx4 v247, s[60:63], s9 offen offset:1024 lds
  buffer_load_dwordx4 v248, s[60:63], s9 offen offset:2048 lds
  buffer_load_dwordx4 v249, s[60:63], s9 offen offset:3072 lds
  v_min_u32 v4, 55, v1
  s_lshr_b32 s6, s55, 3
  s_lshl_b32 s6, s6, 2
  s_add_u32 s6, s6, s57
  s_mul_i32 s6, s6, 3584
  s_add_u32 s6, s6, 65536
  v_lshl_add_u32 v12, v4, 6, s6
  v_lshrrev_b32 v4, 3, v0
  v_and_b32 v5, 7, v0
  v_mul_u32_u24 v6, 4224, v4
  v_lshl_add_u32 v6, v5, 4, v6
  s_lshl_b32 s6, s55, 7
  s_add_u32 s6, s6, 262144
  v_add_u32 v6, s6, v6
  s_mul_i32 s7, s56, 270336
  v_add_u32 v7, s7, v6
  v_bfe_u32 v8, v4, 1, 1
  v_lshlrev_b32 v8, 2, v8
  v_xor_b32 v8, v8, v5
  v_lshlrev_b32 v8, 4, v8
  v_lshl_add_u32 v8, v4, 7, v8
  v_add_u32 v8, 106496, v8
  v_lshlrev_b32 v9, 3, v4
  v_add_u32 v9, 98304, v9
  v_lshrrev_b32 v10, 5, v1
  v_lshlrev_b32_e64 v10, 8, v10
  v_bfe_u32 v11, v1, 4, 1
  v_lshl_add_u32 v10, v11, 4, v10
  v_lshl_add_u32 v10, v5, 5, v10
  s_lshl_b32 s6, s57, 9
  s_add_u32 s6, s6, 101888
  v_add_u32 v10, s6, v10
  v_lshlrev_b32_e64 v11, 5, v5
  v_add_u32 v11, 101888, v11
  ds_read_b64 v[200:201], v9 offset:0
  ds_read_b64 v[202:203], v9 offset:256
  ds_read_b64 v[204:205], v9 offset:512
  ds_read_b64 v[206:207], v9 offset:768
  ds_read_b64 v[208:209], v9 offset:1024
  ds_read_b64 v[210:211], v9 offset:1280
  ds_read_b64 v[212:213], v9 offset:1536
  ds_read_b64 v[214:215], v9 offset:1792
  ds_read_b64 v[216:217], v9 offset:2048
  ds_read_b64 v[218:219], v9 offset:2304
  ds_read_b64 v[220:221], v9 offset:2560
  ds_read_b64 v[222:223], v9 offset:2816
  ds_read_b64 v[224:225], v9 offset:3072
  ds_read_b64 v[226:227], v9 offset:3328
  global_load_dword v16, v12, s[48:49] sc1
  s_waitcnt vmcnt(0)
  v_xor_b32 v2, s50, v16
  v_cmp_ne_u32 vcc, 0, v2
  s_mov_b32 s8, 0
  s_cbranch_vccz L_poll1_done
L_poll1:
  s_sleep 4
  global_load_dword v16, v12, s[48:49] sc1
  s_waitcnt vmcnt(0)
  v_xor_b32_e64 v2, s50, v16
  v_cmp_ne_u32 vcc, 0, v2
  s_add_u32 s8, s8, 1
  s_cbranch_vccz L_poll1_done
  s_cmp_lt_u32 s8, 0x40000
  s_cbranch_scc1 L_poll1
L_poll1_done:
  s_barrier
  global_load_dwordx4 v[16:19], v6, s[48:49] sc1
  v_add_u32 v6, 135168, v6
  global_load_dwordx4 v[20:23], v6, s[48:49] sc1
  v_add_u32 v6, 135168, v6
  global_load_dwordx4 v[24:27], v6, s[48:49] sc1
  v_add_u32 v6, 135168, v6
  global_load_dwordx4 v[28:31], v6, s[48:49] sc1
  v_add_u32 v6, 135168, v6
  global_load_dwordx4 v[32:35], v6, s[48:49] sc1
  v_add_u32 v6, 135168, v6
  global_load_dwordx4 v[36:39], v6, s[48:49] sc1
  v_add_u32 v6, 135168, v6
  global_load_dwordx4 v[40:43], v6, s[48:49] sc1
  v_add_u32 v6, 135168, v6
  global_load_dwordx4 v[44:47], v6, s[48:49] sc1
  v_add_u32 v6, 135168, v6
  global_load_dwordx4 v[48:51], v6, s[48:49] sc1
  v_add_u32 v6, 135168, v6
  global_load_dwordx4 v[52:55], v6, s[48:49] sc1
  v_add_u32 v6, 135168, v6
  global_load_dwordx4 v[56:59], v6, s[48:49] sc1
  v_add_u32 v6, 135168, v6
  global_load_dwordx4 v[60:63], v6, s[48:49] sc1
  v_add_u32 v6, 135168, v6
  global_load_dwordx4 v[64:67], v6, s[48:49] sc1
  v_add_u32 v6, 135168, v6
  global_load_dwordx4 v[68:71], v6, s[48:49] sc1
  global_load_dwordx4 v[228:231], v7, s[48:49] sc1
  v_add_u32 v7, 135168, v7
  global_load_dwordx4 v[232:235], v7, s[48:49] sc1
  ds_read_b64_tr_b16 a[48:49], v242 offset:0
  ds_read_b64_tr_b16 a[50:51], v242 offset:1024
  ds_read_b64_tr_b16 a[160:161], v243 offset:0
  ds_read_b64_tr_b16 a[162:163], v243 offset:1024
  ds_read_b64_tr_b16 a[52:53], v242 offset:2048
  ds_read_b64_tr_b16 a[54:55], v242 offset:3072
  ds_read_b64_tr_b16 a[164:165], v243 offset:2048
  ds_read_b64_tr_b16 a[166:167], v243 offset:3072
  ds_read_b64_tr_b16 a[56:57], v242 offset:4096
  ds_read_b64_tr_b16 a[58:59], v242 offset:5120
  ds_read_b64_tr_b16 a[168:169], v243 offset:4096
  ds_read_b64_tr_b16 a[170:171], v243 offset:5120
  ds_read_b64_tr_b16 a[60:61], v242 offset:6144
  ds_read_b64_tr_b16 a[62:63], v242 offset:7168
  ds_read_b64_tr_b16 a[172:173], v243 offset:6144
  ds_read_b64_tr_b16 a[174:175], v243 offset:7168
  ds_read_b64_tr_b16 a[64:65], v242 offset:8192
  ds_read_b64_tr_b16 a[66:67], v242 offset:9216
  ds_read_b64_tr_b16 a[176:177], v243 offset:8192
  ds_read_b64_tr_b16 a[178:179], v243 offset:9216
  ds_read_b64_tr_b16 a[68:69], v242 offset:10240
  ds_read_b64_tr_b16 a[70:71], v242 offset:11264
  ds_read_b64_tr_b16 a[180:181], v243 offset:10240
  ds_read_b64_tr_b16 a[182:183], v243 offset:11264
  ds_read_b64_tr_b16 a[72:73], v242 offset:12288
  ds_read_b64_tr_b16 a[74:75], v242 offset:13312
  ds_read_b64_tr_b16 a[184:185], v243 offset:12288
  ds_read_b64_tr_b16 a[186:187], v243 offset:13312
  ds_read_b64_tr_b16 a[76:77], v242 offset:14336
  ds_read_b64_tr_b16 a[78:79], v242 offset:15360
  ds_read_b64_tr_b16 a[188:189], v243 offset:14336
  ds_read_b64_tr_b16 a[190:191], v243 offset:15360
  ds_read_b64_tr_b16 a[80:81], v242 offset:16384
  ds_read_b64_tr_b16 a[82:83], v242 offset:17408
  ds_read_b64_tr_b16 a[192:193], v243 offset:16384
  ds_read_b64_tr_b16 a[194:195], v243 offset:17408
  ds_read_b64_tr_b16 a[84:85], v242 offset:18432
  ds_read_b64_tr_b16 a[86:87], v242 offset:19456
  ds_read_b64_tr_b16 a[196:197], v243 offset:18432
  ds_read_b64_tr_b16 a[198:199], v243 offset:19456
  ds_read_b64_tr_b16 a[88:89], v242 offset:20480
  ds_read_b64_tr_b16 a[90:91], v242 offset:21504
  ds_read_b64_tr_b16 a[200:201], v243 offset:20480
  ds_read_b64_tr_b16 a[202:203], v243 offset:21504
  ds_read_b64_tr_b16 a[92:93], v242 offset:22528
  ds_read_b64_tr_b16 a[94:95], v242 offset:23552
  ds_read_b64_tr_b16 a[204:205], v243 offset:22528
  ds_read_b64_tr_b16 a[206:207], v243 offset:23552
  ds_read_b64_tr_b16 a[96:97], v244 offset:0
  ds_read_b64_tr_b16 a[98:99], v244 offset:1024
  ds_read_b64_tr_b16 a[208:209], v245 offset:0
  ds_read_b64_tr_b16 a[210:211], v245 offset:1024
  ds_read_b64_tr_b16 a[100:101], v244 offset:2048
  ds_read_b64_tr_b16 a[102:103], v244 offset:3072
  ds_read_b64_tr_b16 a[212:213], v245 offset:2048
  ds_read_b64_tr_b16 a[214:215], v245 offset:3072
  ds_read_b64_tr_b16 a[104:105], v244 offset:4096
  ds_read_b64_tr_b16 a[106:107], v244 offset:5120
  ds_read_b64_tr_b16 a[216:217], v245 offset:4096
  ds_read_b64_tr_b16 a[218:219], v245 offset:5120
  ds_read_b64_tr_b16 a[108:109], v244 offset:6144
  ds_read_b64_tr_b16 a[110:111], v244 offset:7168
  ds_read_b64_tr_b16 a[220:221], v245 offset:6144
  ds_read_b64_tr_b16 a[222:223], v245 offset:7168
  s_lshl_b32 s7, s5, 6
  v_xor_b32 v242, s7, v242
  v_xor_b32 v243, s7, v243
  s_mul_i32 s6, s57, 12288
  s_add_u32 s6, s6, 106496
  v_xor_b32 v2, s7, v240
  v_xor_b32 v3, s7, v241
  v_add_u32 v244, s6, v2
  v_add_u32 v245, s6, v3
  v_add_u32 v12, 106496, v240
  v_add_u32 v13, 106496, v241
  s_waitcnt lgkmcnt(14)
  s_waitcnt vmcnt(15)
  v_lshlrev_b32 v72, 16, v16
  v_and_b32 v73, 0xffff0000, v16
  v_lshlrev_b32 v74, 16, v17
  v_and_b32 v75, 0xffff0000, v17
  v_lshlrev_b32 v76, 16, v18
  v_and_b32 v77, 0xffff0000, v18
  v_lshlrev_b32_e64 v78, 16, v19
  v_and_b32 v79, 0xffff0000, v19
  v_pk_mul_f32 v[192:193], v[72:73], v[72:73]
  v_pk_mul_f32 v[194:195], v[74:75], v[74:75]
  v_pk_mul_f32 v[196:197], v[76:77], v[76:77]
  v_pk_mul_f32 v[198:199], v[78:79], v[78:79]
  s_waitcnt vmcnt(14)
  v_lshlrev_b32 v80, 16, v20
  v_and_b32 v81, 0xffff0000, v20
  v_lshlrev_b32 v82, 16, v21
  v_and_b32 v83, 0xffff0000, v21
  v_lshlrev_b32 v84, 16, v22
  v_and_b32 v85, 0xffff0000, v22
  v_lshlrev_b32_e64 v86, 16, v23
  v_and_b32 v87, 0xffff0000, v23
  v_pk_add_f32 v[184:185], v[80:81], v[72:73]
  v_pk_fma_f32 v[192:193], v[80:81], v[80:81], v[192:193]
  v_pk_add_f32 v[186:187], v[82:83], v[74:75]
  v_pk_fma_f32 v[194:195], v[82:83], v[82:83], v[194:195]
  v_pk_add_f32 v[188:189], v[84:85], v[76:77]
  v_pk_fma_f32 v[196:197], v[84:85], v[84:85], v[196:197]
  v_pk_add_f32 v[190:191], v[86:87], v[78:79]
  v_pk_fma_f32 v[198:199], v[86:87], v[86:87], v[198:199]
  s_waitcnt vmcnt(13)
  v_lshlrev_b32 v88, 16, v24
  v_and_b32 v89, 0xffff0000, v24
  v_lshlrev_b32 v90, 16, v25
  v_and_b32 v91, 0xffff0000, v25
  v_lshlrev_b32 v92, 16, v26
  v_and_b32 v93, 0xffff0000, v26
  v_lshlrev_b32_e64 v94, 16, v27
  v_and_b32 v95, 0xffff0000, v27
  v_pk_add_f32 v[184:185], v[88:89], v[184:185]
  v_pk_fma_f32 v[192:193], v[88:89], v[88:89], v[192:193]
  v_pk_add_f32 v[186:187], v[90:91], v[186:187]
  v_pk_fma_f32 v[194:195], v[90:91], v[90:91], v[194:195]
  v_pk_add_f32 v[188:189], v[92:93], v[188:189]
  v_pk_fma_f32 v[196:197], v[92:93], v[92:93], v[196:197]
  v_pk_add_f32 v[190:191], v[94:95], v[190:191]
  v_pk_fma_f32 v[198:199], v[94:95], v[94:95], v[198:199]
  s_waitcnt vmcnt(12)
  v_lshlrev_b32 v96, 16, v28
  v_and_b32 v97, 0xffff0000, v28
  v_lshlrev_b32 v98, 16, v29
  v_and_b32 v99, 0xffff0000, v29
  v_lshlrev_b32 v100, 16, v30
  v_and_b32 v101, 0xffff0000, v30
  v_lshlrev_b32_e64 v102, 16, v31
  v_and_b32 v103, 0xffff0000, v31
  v_pk_add_f32 v[184:185], v[96:97], v[184:185]
  v_pk_fma_f32 v[192:193], v[96:97], v[96:97], v[192:193]
  v_pk_add_f32 v[186:187], v[98:99], v[186:187]
  v_pk_fma_f32 v[194:195], v[98:99], v[98:99], v[194:195]
  v_pk_add_f32 v[188:189], v[100:101], v[188:189]
  v_pk_fma_f32 v[196:197], v[100:101], v[100:101], v[196:197]
  v_pk_add_f32 v[190:191], v[102:103], v[190:191]
  v_pk_fma_f32 v[198:199], v[102:103], v[102:103], v[198:199]
  s_waitcnt vmcnt(11)
  v_lshlrev_b32 v104, 16, v32
  v_and_b32 v105, 0xffff0000, v32
  v_lshlrev_b32 v106, 16, v33
  v_and_b32 v107, 0xffff0000, v33
  v_lshlrev_b32 v108, 16, v34
  v_and_b32 v109, 0xffff0000, v34
  v_lshlrev_b32_e64 v110, 16, v35
  v_and_b32 v111, 0xffff0000, v35
  v_pk_add_f32 v[184:185], v[104:105], v[184:185]
  v_pk_fma_f32 v[192:193], v[104:105], v[104:105], v[192:193]
  v_pk_add_f32 v[186:187], v[106:107], v[186:187]
  v_pk_fma_f32 v[194:195], v[106:107], v[106:107], v[194:195]
  v_pk_add_f32 v[188:189], v[108:109], v[188:189]
  v_pk_fma_f32 v[196:197], v[108:109], v[108:109], v[196:197]
  v_pk_add_f32 v[190:191], v[110:111], v[190:191]
  v_pk_fma_f32 v[198:199], v[110:111], v[110:111], v[198:199]
  s_waitcnt vmcnt(10)
  v_lshlrev_b32 v112, 16, v36
  v_and_b32 v113, 0xffff0000, v36
  v_lshlrev_b32 v114, 16, v37
  v_and_b32 v115, 0xffff0000, v37
  v_lshlrev_b32 v116, 16, v38
  v_and_b32 v117, 0xffff0000, v38
  v_lshlrev_b32_e64 v118, 16, v39
  v_and_b32 v119, 0xffff0000, v39
  v_pk_add_f32 v[184:185], v[112:113], v[184:185]
  v_pk_fma_f32 v[192:193], v[112:113], v[112:113], v[192:193]
  v_pk_add_f32 v[186:187], v[114:115], v[186:187]
  v_pk_fma_f32 v[194:195], v[114:115], v[114:115], v[194:195]
  v_pk_add_f32 v[188:189], v[116:117], v[188:189]
  v_pk_fma_f32 v[196:197], v[116:117], v[116:117], v[196:197]
  v_pk_add_f32 v[190:191], v[118:119], v[190:191]
  v_pk_fma_f32 v[198:199], v[118:119], v[118:119], v[198:199]
  s_waitcnt vmcnt(9)
  v_lshlrev_b32 v120, 16, v40
  v_and_b32 v121, 0xffff0000, v40
  v_lshlrev_b32 v122, 16, v41
  v_and_b32 v123, 0xffff0000, v41
  v_lshlrev_b32 v124, 16, v42
  v_and_b32 v125, 0xffff0000, v42
  v_lshlrev_b32_e64 v126, 16, v43
  v_and_b32 v127, 0xffff0000, v43
  v_pk_add_f32 v[184:185], v[120:121], v[184:185]
  v_pk_fma_f32 v[192:193], v[120:121], v[120:121], v[192:193]
  v_pk_add_f32 v[186:187], v[122:123], v[186:187]
  v_pk_fma_f32 v[194:195], v[122:123], v[122:123], v[194:195]
  v_pk_add_f32 v[188:189], v[124:125], v[188:189]
  v_pk_fma_f32 v[196:197], v[124:125], v[124:125], v[196:197]
  v_pk_add_f32 v[190:191], v[126:127], v[190:191]
  v_pk_fma_f32 v[198:199], v[126:127], v[126:127], v[198:199]
  s_waitcnt vmcnt(8)
  v_lshlrev_b32 v128, 16, v44
  v_and_b32 v129, 0xffff0000, v44
  v_lshlrev_b32 v130, 16, v45
  v_and_b32 v131, 0xffff0000, v45
  v_lshlrev_b32 v132, 16, v46
  v_and_b32 v133, 0xffff0000, v46
  v_lshlrev_b32_e64 v134, 16, v47
  v_and_b32 v135, 0xffff0000, v47
  v_pk_add_f32 v[184:185], v[128:129], v[184:185]
  v_pk_fma_f32 v[192:193], v[128:129], v[128:129], v[192:193]
  v_pk_add_f32 v[186:187], v[130:131], v[186:187]
  v_pk_fma_f32 v[194:195], v[130:131], v[130:131], v[194:195]
  v_pk_add_f32 v[188:189], v[132:133], v[188:189]
  v_pk_fma_f32 v[196:197], v[132:133], v[132:133], v[196:197]
  v_pk_add_f32 v[190:191], v[134:135], v[190:191]
  v_pk_fma_f32 v[198:199], v[134:135], v[134:135], v[198:199]
  s_waitcnt vmcnt(7)
  v_lshlrev_b32 v136, 16, v48
  v_and_b32 v137, 0xffff0000, v48
  v_lshlrev_b32 v138, 16, v49
  v_and_b32 v139, 0xffff0000, v49
  v_lshlrev_b32 v140, 16, v50
  v_and_b32 v141, 0xffff0000, v50
  v_lshlrev_b32_e64 v142, 16, v51
  v_and_b32 v143, 0xffff0000, v51
  v_pk_add_f32 v[184:185], v[136:137], v[184:185]
  v_pk_fma_f32 v[192:193], v[136:137], v[136:137], v[192:193]
  v_pk_add_f32 v[186:187], v[138:139], v[186:187]
  v_pk_fma_f32 v[194:195], v[138:139], v[138:139], v[194:195]
  v_pk_add_f32 v[188:189], v[140:141], v[188:189]
  v_pk_fma_f32 v[196:197], v[140:141], v[140:141], v[196:197]
  v_pk_add_f32 v[190:191], v[142:143], v[190:191]
  v_pk_fma_f32 v[198:199], v[142:143], v[142:143], v[198:199]
  s_waitcnt vmcnt(6)
  v_lshlrev_b32 v144, 16, v52
  v_and_b32 v145, 0xffff0000, v52
  v_lshlrev_b32 v146, 16, v53
  v_and_b32 v147, 0xffff0000, v53
  v_lshlrev_b32 v148, 16, v54
  v_and_b32 v149, 0xffff0000, v54
  v_lshlrev_b32_e64 v150, 16, v55
  v_and_b32 v151, 0xffff0000, v55
  v_pk_add_f32 v[184:185], v[144:145], v[184:185]
  v_pk_fma_f32 v[192:193], v[144:145], v[144:145], v[192:193]
  v_pk_add_f32 v[186:187], v[146:147], v[186:187]
  v_pk_fma_f32 v[194:195], v[146:147], v[146:147], v[194:195]
  v_pk_add_f32 v[188:189], v[148:149], v[188:189]
  v_pk_fma_f32 v[196:197], v[148:149], v[148:149], v[196:197]
  v_pk_add_f32 v[190:191], v[150:151], v[190:191]
  v_pk_fma_f32 v[198:199], v[150:151], v[150:151], v[198:199]
  s_waitcnt vmcnt(5)
  v_lshlrev_b32 v152, 16, v56
  v_and_b32 v153, 0xffff0000, v56
  v_lshlrev_b32 v154, 16, v57
  v_and_b32 v155, 0xffff0000, v57
  v_lshlrev_b32 v156, 16, v58
  v_and_b32 v157, 0xffff0000, v58
  v_lshlrev_b32_e64 v158, 16, v59
  v_and_b32 v159, 0xffff0000, v59
  v_pk_add_f32 v[184:185], v[152:153], v[184:185]
  v_pk_fma_f32 v[192:193], v[152:153], v[152:153], v[192:193]
  v_pk_add_f32 v[186:187], v[154:155], v[186:187]
  v_pk_fma_f32 v[194:195], v[154:155], v[154:155], v[194:195]
  v_pk_add_f32 v[188:189], v[156:157], v[188:189]
  v_pk_fma_f32 v[196:197], v[156:157], v[156:157], v[196:197]
  v_pk_add_f32 v[190:191], v[158:159], v[190:191]
  v_pk_fma_f32 v[198:199], v[158:159], v[158:159], v[198:199]
  s_mul_i32 s15, s57, 24576
  s_add_u32 s15, s15, 0
  s_add_u32 m0, s15, 0
  s_mov_b32 s9, 0
  buffer_load_dwordx4 v250, s[64:67], s9 offen offset:0 lds
  s_waitcnt vmcnt(5)
  v_lshlrev_b32 v160, 16, v60
  v_and_b32 v161, 0xffff0000, v60
  v_lshlrev_b32 v162, 16, v61
  v_and_b32 v163, 0xffff0000, v61
  v_lshlrev_b32 v164, 16, v62
  v_and_b32 v165, 0xffff0000, v62
  v_lshlrev_b32 v166, 16, v63
  v_and_b32 v167, 0xffff0000, v63
  v_pk_add_f32 v[184:185], v[160:161], v[184:185]
  v_pk_fma_f32 v[192:193], v[160:161], v[160:161], v[192:193]
  v_pk_add_f32 v[186:187], v[162:163], v[186:187]
  v_pk_fma_f32 v[194:195], v[162:163], v[162:163], v[194:195]
  v_pk_add_f32 v[188:189], v[164:165], v[188:189]
  v_pk_fma_f32 v[196:197], v[164:165], v[164:165], v[196:197]
  v_pk_add_f32 v[190:191], v[166:167], v[190:191]
  v_pk_fma_f32 v[198:199], v[166:167], v[166:167], v[198:199]
  buffer_load_dwordx4 v251, s[64:67], s9 offen offset:1024 lds
  s_waitcnt vmcnt(5)
  v_lshlrev_b32 v168, 16, v64
  v_and_b32 v169, 0xffff0000, v64
  v_lshlrev_b32 v170, 16, v65
  v_and_b32 v171, 0xffff0000, v65
  v_lshlrev_b32 v172, 16, v66
  v_and_b32 v173, 0xffff0000, v66
  v_lshlrev_b32_e64 v174, 16, v67
  v_and_b32 v175, 0xffff0000, v67
  v_pk_add_f32 v[184:185], v[168:169], v[184:185]
  v_pk_fma_f32 v[192:193], v[168:169], v[168:169], v[192:193]
  v_pk_add_f32 v[186:187], v[170:171], v[186:187]
  v_pk_fma_f32 v[194:195], v[170:171], v[170:171], v[194:195]
  v_pk_add_f32 v[188:189], v[172:173], v[188:189]
  v_pk_fma_f32 v[196:197], v[172:173], v[172:173], v[196:197]
  v_pk_add_f32 v[190:191], v[174:175], v[190:191]
  v_pk_fma_f32 v[198:199], v[174:175], v[174:175], v[198:199]
  buffer_load_dwordx4 v252, s[64:67], s9 offen offset:2048 lds
  s_waitcnt vmcnt(5)
  v_lshlrev_b32 v176, 16, v68
  v_and_b32 v177, 0xffff0000, v68
  v_lshlrev_b32 v178, 16, v69
  v_and_b32 v179, 0xffff0000, v69
  v_lshlrev_b32 v180, 16, v70
  v_and_b32 v181, 0xffff0000, v70
  v_lshlrev_b32_e64 v182, 16, v71
  v_and_b32 v183, 0xffff0000, v71
  v_pk_add_f32 v[184:185], v[176:177], v[184:185]
  v_pk_fma_f32 v[192:193], v[176:177], v[176:177], v[192:193]
  v_pk_add_f32 v[186:187], v[178:179], v[186:187]
  v_pk_fma_f32 v[194:195], v[178:179], v[178:179], v[194:195]
  v_pk_add_f32 v[188:189], v[180:181], v[188:189]
  v_pk_fma_f32 v[196:197], v[180:181], v[180:181], v[196:197]
  v_pk_add_f32 v[190:191], v[182:183], v[190:191]
  v_pk_fma_f32 v[198:199], v[182:183], v[182:183], v[198:199]
  buffer_load_dwordx4 v253, s[64:67], s9 offen offset:3072 lds
  v_permlane32_swap_b32 v184, v192
  v_permlane32_swap_b32 v185, v193
  v_permlane32_swap_b32 v186, v194
  v_permlane32_swap_b32 v187, v195
  v_permlane32_swap_b32 v188, v196
  v_permlane32_swap_b32 v189, v197
  v_permlane32_swap_b32 v190, v198
  v_permlane32_swap_b32 v191, v199
  v_pk_add_f32 v[184:185], v[184:185], v[192:193]
  v_pk_add_f32 v[186:187], v[186:187], v[194:195]
  v_pk_add_f32 v[188:189], v[188:189], v[196:197]
  v_pk_add_f32 v[190:191], v[190:191], v[198:199]
  s_nop 0
  v_permlane16_swap_b32 v184, v188
  v_permlane16_swap_b32 v185, v189
  v_permlane16_swap_b32 v186, v190
  v_permlane16_swap_b32 v187, v191
  s_nop 0
  v_pk_add_f32 v[184:185], v[184:185], v[188:189]
  v_pk_add_f32 v[186:187], v[186:187], v[190:191]
  s_add_u32 m0, s15, 4096
  s_mov_b32 s9, 28672
  buffer_load_dwordx4 v250, s[64:67], s9 offen offset:0 lds
  v_add_f32_dpp v184, v184, v184 row_ror:8 row_mask:0xf bank_mask:0xf
  v_add_f32_dpp v185, v185, v185 row_ror:8 row_mask:0xf bank_mask:0xf
  v_add_f32_dpp v186, v186, v186 row_ror:8 row_mask:0xf bank_mask:0xf
  v_add_f32_dpp v187, v187, v187 row_ror:8 row_mask:0xf bank_mask:0xf
  ds_write_b128 v10, v[184:187]
  buffer_load_dwordx4 v251, s[64:67], s9 offen offset:1024 lds
  buffer_load_dwordx4 v252, s[64:67], s9 offen offset:2048 lds
  s_waitcnt lgkmcnt(0)
  s_barrier
  ds_read_b128 v[16:19], v11 offset:0
  ds_read_b128 v[20:23], v11 offset:16
  ds_read_b128 v[24:27], v11 offset:256
  ds_read_b128 v[28:31], v11 offset:272
  ds_read_b128 v[32:35], v11 offset:512
  ds_read_b128 v[36:39], v11 offset:528
  ds_read_b128 v[40:43], v11 offset:768
  ds_read_b128 v[44:47], v11 offset:784
  ds_read_b128 v[48:51], v11 offset:1024
  ds_read_b128 v[52:55], v11 offset:1040
  ds_read_b128 v[56:59], v11 offset:1280
  ds_read_b128 v[60:63], v11 offset:1296
  ds_read_b128 v[64:67], v11 offset:1536
  ds_read_b128 v[68:71], v11 offset:1552
  ds_read_b128 v[184:187], v11 offset:1792
  ds_read_b128 v[188:191], v11 offset:1808
  s_cmp_lg_u32 s2, 0
  s_cbranch_scc1 L_nobump
  v_mov_b32 v2, s51
  v_mov_b32 v3, 0
  global_store_dword v3, v2, s[48:49] sc1
L_nobump:
  s_waitcnt lgkmcnt(11)
  v_pk_add_f32 v[16:17], v[16:17], v[32:33]
  v_pk_add_f32 v[18:19], v[18:19], v[34:35]
  s_waitcnt lgkmcnt(10)
  v_pk_add_f32 v[20:21], v[20:21], v[36:37]
  v_pk_add_f32 v[22:23], v[22:23], v[38:39]
  s_waitcnt lgkmcnt(9)
  v_pk_add_f32 v[24:25], v[24:25], v[40:41]
  v_pk_add_f32 v[26:27], v[26:27], v[42:43]
  s_waitcnt lgkmcnt(8)
  v_pk_add_f32 v[28:29], v[28:29], v[44:45]
  v_pk_add_f32 v[30:31], v[30:31], v[46:47]
  s_waitcnt lgkmcnt(3)
  v_pk_add_f32 v[48:49], v[48:49], v[64:65]
  v_pk_add_f32 v[50:51], v[50:51], v[66:67]
  s_waitcnt lgkmcnt(2)
  v_pk_add_f32 v[52:53], v[52:53], v[68:69]
  v_pk_add_f32 v[54:55], v[54:55], v[70:71]
  s_waitcnt lgkmcnt(1)
  v_pk_add_f32 v[56:57], v[56:57], v[184:185]
  v_pk_add_f32 v[58:59], v[58:59], v[186:187]
  s_waitcnt lgkmcnt(0)
  v_pk_add_f32 v[60:61], v[60:61], v[188:189]
  v_pk_add_f32 v[62:63], v[62:63], v[190:191]
  v_pk_add_f32 v[16:17], v[16:17], v[48:49]
  v_pk_add_f32 v[18:19], v[18:19], v[50:51]
  v_pk_add_f32 v[20:21], v[20:21], v[52:53]
  v_pk_add_f32 v[22:23], v[22:23], v[54:55]
  v_pk_add_f32 v[24:25], v[24:25], v[56:57]
  v_pk_add_f32 v[26:27], v[26:27], v[58:59]
  v_pk_add_f32 v[28:29], v[28:29], v[60:61]
  v_pk_add_f32 v[30:31], v[30:31], v[62:63]
  s_mov_b32 s6, 0x3b124925
  s_mov_b32 s7, 0x3727c5ac
  v_pk_mul_f32 v[16:17], v[16:17], s[6:7] op_sel_hi:[1,0]
  v_pk_mul_f32 v[18:19], v[18:19], s[6:7] op_sel_hi:[1,0]
  v_pk_mul_f32 v[20:21], v[20:21], s[6:7] op_sel_hi:[1,0]
  v_pk_mul_f32 v[22:23], v[22:23], s[6:7] op_sel_hi:[1,0]
  v_pk_mul_f32 v[24:25], v[24:25], s[6:7] op_sel_hi:[1,0]
  v_pk_mul_f32 v[26:27], v[26:27], s[6:7] op_sel_hi:[1,0]
  v_pk_mul_f32 v[28:29], v[28:29], s[6:7] op_sel_hi:[1,0]
  v_pk_mul_f32 v[30:31], v[30:31], s[6:7] op_sel_hi:[1,0]
  v_pk_fma_f32 v[24:25], v[16:17], v[16:17], v[24:25] neg_lo:[1,0,0] neg_hi:[1,0,0]
  v_pk_fma_f32 v[26:27], v[18:19], v[18:19], v[26:27] neg_lo:[1,0,0] neg_hi:[1,0,0]
  v_pk_fma_f32 v[28:29], v[20:21], v[20:21], v[28:29] neg_lo:[1,0,0] neg_hi:[1,0,0]
  v_pk_fma_f32 v[30:31], v[22:23], v[22:23], v[30:31] neg_lo:[1,0,0] neg_hi:[1,0,0]
  v_pk_add_f32 v[24:25], v[24:25], s[6:7] op_sel:[0,1] op_sel_hi:[1,1]
  v_pk_add_f32 v[26:27], v[26:27], s[6:7] op_sel:[0,1] op_sel_hi:[1,1]
  v_pk_add_f32 v[28:29], v[28:29], s[6:7] op_sel:[0,1] op_sel_hi:[1,1]
  v_pk_add_f32 v[30:31], v[30:31], s[6:7] op_sel:[0,1] op_sel_hi:[1,1]
  v_max_f32 v24, s7, v24
  v_max_f32 v25, s7, v25
  v_max_f32 v26, s7, v26
  v_max_f32 v27, s7, v27
  v_max_f32 v28, s7, v28
  v_max_f32 v29, s7, v29
  v_max_f32 v30, s7, v30
  v_max_f32 v31, s7, v31
  v_rsq_f32 v24, v24
  v_rsq_f32 v25, v25
  v_rsq_f32 v26, v26
  v_rsq_f32 v27, v27
  v_rsq_f32 v28, v28
  v_rsq_f32 v29, v29
  v_rsq_f32 v30, v30
  v_rsq_f32 v31, v31
  buffer_load_dwordx4 v253, s[64:67], s9 offen offset:3072 lds
  v_pk_mul_f32 v[16:17], v[16:17], v[24:25] neg_lo:[1,0] neg_hi:[1,0]
  v_pk_mul_f32 v[18:19], v[18:19], v[26:27] neg_lo:[1,0] neg_hi:[1,0]
  v_pk_mul_f32 v[20:21], v[20:21], v[28:29] neg_lo:[1,0] neg_hi:[1,0]
  v_pk_mul_f32 v[22:23], v[22:23], v[30:31] neg_lo:[1,0] neg_hi:[1,0]
  v_pk_fma_f32 v[72:73], v[72:73], v[24:25], v[16:17]
  v_pk_fma_f32 v[74:75], v[74:75], v[26:27], v[18:19]
  v_pk_fma_f32 v[76:77], v[76:77], v[28:29], v[20:21]
  v_pk_fma_f32 v[78:79], v[78:79], v[30:31], v[22:23]
  v_pk_fma_f32 v[72:73], v[72:73], v[200:201], v[200:201] op_sel:[0,0,1] op_sel_hi:[1,0,1]
  v_pk_fma_f32 v[74:75], v[74:75], v[200:201], v[200:201] op_sel:[0,0,1] op_sel_hi:[1,0,1]
  v_pk_fma_f32 v[76:77], v[76:77], v[200:201], v[200:201] op_sel:[0,0,1] op_sel_hi:[1,0,1]
  v_pk_fma_f32 v[78:79], v[78:79], v[200:201], v[200:201] op_sel:[0,0,1] op_sel_hi:[1,0,1]
  v_cvt_pk_bf16_f32 v32, v72, v73
  v_cvt_pk_bf16_f32 v33, v74, v75
  v_cvt_pk_bf16_f32 v34, v76, v77
  v_cvt_pk_bf16_f32 v35, v78, v79
  ds_write_b128 v8, v[32:35] offset:0
  v_pk_fma_f32 v[80:81], v[80:81], v[24:25], v[16:17]
  v_pk_fma_f32 v[82:83], v[82:83], v[26:27], v[18:19]
  v_pk_fma_f32 v[84:85], v[84:85], v[28:29], v[20:21]
  v_pk_fma_f32 v[86:87], v[86:87], v[30:31], v[22:23]
  v_pk_fma_f32 v[80:81], v[80:81], v[202:203], v[202:203] op_sel:[0,0,1] op_sel_hi:[1,0,1]
  v_pk_fma_f32 v[82:83], v[82:83], v[202:203], v[202:203] op_sel:[0,0,1] op_sel_hi:[1,0,1]
  v_pk_fma_f32 v[84:85], v[84:85], v[202:203], v[202:203] op_sel:[0,0,1] op_sel_hi:[1,0,1]
  v_pk_fma_f32 v[86:87], v[86:87], v[202:203], v[202:203] op_sel:[0,0,1] op_sel_hi:[1,0,1]
  v_cvt_pk_bf16_f32 v36, v80, v81
  v_cvt_pk_bf16_f32 v37, v82, v83
  v_cvt_pk_bf16_f32 v38, v84, v85
  v_cvt_pk_bf16_f32 v39, v86, v87
  ds_write_b128 v8, v[36:39] offset:4096
  s_add_u32 m0, s15, 8192
  s_mov_b32 s9, 57344
  buffer_load_dwordx4 v250, s[64:67], s9 offen offset:0 lds
  v_pk_fma_f32 v[88:89], v[88:89], v[24:25], v[16:17]
  v_pk_fma_f32 v[90:91], v[90:91], v[26:27], v[18:19]
  v_pk_fma_f32 v[92:93], v[92:93], v[28:29], v[20:21]
  v_pk_fma_f32 v[94:95], v[94:95], v[30:31], v[22:23]
  v_pk_fma_f32 v[88:89], v[88:89], v[204:205], v[204:205] op_sel:[0,0,1] op_sel_hi:[1,0,1]
  v_pk_fma_f32 v[90:91], v[90:91], v[204:205], v[204:205] op_sel:[0,0,1] op_sel_hi:[1,0,1]
  v_pk_fma_f32 v[92:93], v[92:93], v[204:205], v[204:205] op_sel:[0,0,1] op_sel_hi:[1,0,1]
  v_pk_fma_f32 v[94:95], v[94:95], v[204:205], v[204:205] op_sel:[0,0,1] op_sel_hi:[1,0,1]
  v_cvt_pk_bf16_f32 v40, v88, v89
  v_cvt_pk_bf16_f32 v41, v90, v91
  v_cvt_pk_bf16_f32 v42, v92, v93
  v_cvt_pk_bf16_f32 v43, v94, v95
  ds_write_b128 v8, v[40:43] offset:8192
  v_pk_fma_f32 v[96:97], v[96:97], v[24:25], v[16:17]
  v_pk_fma_f32 v[98:99], v[98:99], v[26:27], v[18:19]
  v_pk_fma_f32 v[100:101], v[100:101], v[28:29], v[20:21]
  v_pk_fma_f32 v[102:103], v[102:103], v[30:31], v[22:23]
  v_pk_fma_f32 v[96:97], v[96:97], v[206:207], v[206:207] op_sel:[0,0,1] op_sel_hi:[1,0,1]
  v_pk_fma_f32 v[98:99], v[98:99], v[206:207], v[206:207] op_sel:[0,0,1] op_sel_hi:[1,0,1]
  v_pk_fma_f32 v[100:101], v[100:101], v[206:207], v[206:207] op_sel:[0,0,1] op_sel_hi:[1,0,1]
  v_pk_fma_f32 v[102:103], v[102:103], v[206:207], v[206:207] op_sel:[0,0,1] op_sel_hi:[1,0,1]
  v_cvt_pk_bf16_f32 v44, v96, v97
  v_cvt_pk_bf16_f32 v45, v98, v99
  v_cvt_pk_bf16_f32 v46, v100, v101
  v_cvt_pk_bf16_f32 v47, v102, v103
  ds_write_b128 v8, v[44:47] offset:12288
  buffer_load_dwordx4 v251, s[64:67], s9 offen offset:1024 lds
  v_pk_fma_f32 v[104:105], v[104:105], v[24:25], v[16:17]
  v_pk_fma_f32 v[106:107], v[106:107], v[26:27], v[18:19]
  v_pk_fma_f32 v[108:109], v[108:109], v[28:29], v[20:21]
  v_pk_fma_f32 v[110:111], v[110:111], v[30:31], v[22:23]
  v_pk_fma_f32 v[104:105], v[104:105], v[208:209], v[208:209] op_sel:[0,0,1] op_sel_hi:[1,0,1]
  v_pk_fma_f32 v[106:107], v[106:107], v[208:209], v[208:209] op_sel:[0,0,1] op_sel_hi:[1,0,1]
  v_pk_fma_f32 v[108:109], v[108:109], v[208:209], v[208:209] op_sel:[0,0,1] op_sel_hi:[1,0,1]
  v_pk_fma_f32 v[110:111], v[110:111], v[208:209], v[208:209] op_sel:[0,0,1] op_sel_hi:[1,0,1]
  v_cvt_pk_bf16_f32 v32, v104, v105
  v_cvt_pk_bf16_f32 v33, v106, v107
  v_cvt_pk_bf16_f32 v34, v108, v109
  v_cvt_pk_bf16_f32 v35, v110, v111
  ds_write_b128 v8, v[32:35] offset:16384
  v_pk_fma_f32 v[112:113], v[112:113], v[24:25], v[16:17]
  v_pk_fma_f32 v[114:115], v[114:115], v[26:27], v[18:19]
  v_pk_fma_f32 v[116:117], v[116:117], v[28:29], v[20:21]
  v_pk_fma_f32 v[118:119], v[118:119], v[30:31], v[22:23]
  v_pk_fma_f32 v[112:113], v[112:113], v[210:211], v[210:211] op_sel:[0,0,1] op_sel_hi:[1,0,1]
  v_pk_fma_f32 v[114:115], v[114:115], v[210:211], v[210:211] op_sel:[0,0,1] op_sel_hi:[1,0,1]
  v_pk_fma_f32 v[116:117], v[116:117], v[210:211], v[210:211] op_sel:[0,0,1] op_sel_hi:[1,0,1]
  v_pk_fma_f32 v[118:119], v[118:119], v[210:211], v[210:211] op_sel:[0,0,1] op_sel_hi:[1,0,1]
  v_cvt_pk_bf16_f32 v36, v112, v113
  v_cvt_pk_bf16_f32 v37, v114, v115
  v_cvt_pk_bf16_f32 v38, v116, v117
  v_cvt_pk_bf16_f32 v39, v118, v119
  ds_write_b128 v8, v[36:39] offset:20480
  buffer_load_dwordx4 v252, s[64:67], s9 offen offset:2048 lds
  v_pk_fma_f32 v[120:121], v[120:121], v[24:25], v[16:17]
  v_pk_fma_f32 v[122:123], v[122:123], v[26:27], v[18:19]
  v_pk_fma_f32 v[124:125], v[124:125], v[28:29], v[20:21]
  v_pk_fma_f32 v[126:127], v[126:127], v[30:31], v[22:23]
  v_pk_fma_f32 v[120:121], v[120:121], v[212:213], v[212:213] op_sel:[0,0,1] op_sel_hi:[1,0,1]
  v_pk_fma_f32 v[122:123], v[122:123], v[212:213], v[212:213] op_sel:[0,0,1] op_sel_hi:[1,0,1]
  v_pk_fma_f32 v[124:125], v[124:125], v[212:213], v[212:213] op_sel:[0,0,1] op_sel_hi:[1,0,1]
  v_pk_fma_f32 v[126:127], v[126:127], v[212:213], v[212:213] op_sel:[0,0,1] op_sel_hi:[1,0,1]
  v_cvt_pk_bf16_f32 v40, v120, v121
  v_cvt_pk_bf16_f32 v41, v122, v123
  v_cvt_pk_bf16_f32 v42, v124, v125
  v_cvt_pk_bf16_f32 v43, v126, v127
  ds_write_b128 v8, v[40:43] offset:24576
  v_pk_fma_f32 v[128:129], v[128:129], v[24:25], v[16:17]
  v_pk_fma_f32 v[130:131], v[130:131], v[26:27], v[18:19]
  v_pk_fma_f32 v[132:133], v[132:133], v[28:29], v[20:21]
  v_pk_fma_f32 v[134:135], v[134:135], v[30:31], v[22:23]
  v_pk_fma_f32 v[128:129], v[128:129], v[214:215], v[214:215] op_sel:[0,0,1] op_sel_hi:[1,0,1]
  v_pk_fma_f32 v[130:131], v[130:131], v[214:215], v[214:215] op_sel:[0,0,1] op_sel_hi:[1,0,1]
  v_pk_fma_f32 v[132:133], v[132:133], v[214:215], v[214:215] op_sel:[0,0,1] op_sel_hi:[1,0,1]
  v_pk_fma_f32 v[134:135], v[134:135], v[214:215], v[214:215] op_sel:[0,0,1] op_sel_hi:[1,0,1]
  v_cvt_pk_bf16_f32 v44, v128, v129
  v_cvt_pk_bf16_f32 v45, v130, v131
  v_cvt_pk_bf16_f32 v46, v132, v133
  v_cvt_pk_bf16_f32 v47, v134, v135
  ds_write_b128 v8, v[44:47] offset:28672
  buffer_load_dwordx4 v253, s[64:67], s9 offen offset:3072 lds
  v_pk_fma_f32 v[136:137], v[136:137], v[24:25], v[16:17]
  v_pk_fma_f32 v[138:139], v[138:139], v[26:27], v[18:19]
  v_pk_fma_f32 v[140:141], v[140:141], v[28:29], v[20:21]
  v_pk_fma_f32 v[142:143], v[142:143], v[30:31], v[22:23]
  v_pk_fma_f32 v[136:137], v[136:137], v[216:217], v[216:217] op_sel:[0,0,1] op_sel_hi:[1,0,1]
  v_pk_fma_f32 v[138:139], v[138:139], v[216:217], v[216:217] op_sel:[0,0,1] op_sel_hi:[1,0,1]
  v_pk_fma_f32 v[140:141], v[140:141], v[216:217], v[216:217] op_sel:[0,0,1] op_sel_hi:[1,0,1]
  v_pk_fma_f32 v[142:143], v[142:143], v[216:217], v[216:217] op_sel:[0,0,1] op_sel_hi:[1,0,1]
  v_cvt_pk_bf16_f32 v32, v136, v137
  v_cvt_pk_bf16_f32 v33, v138, v139
  v_cvt_pk_bf16_f32 v34, v140, v141
  v_cvt_pk_bf16_f32 v35, v142, v143
  ds_write_b128 v8, v[32:35] offset:32768
  v_pk_fma_f32 v[144:145], v[144:145], v[24:25], v[16:17]
  v_pk_fma_f32 v[146:147], v[146:147], v[26:27], v[18:19]
  v_pk_fma_f32 v[148:149], v[148:149], v[28:29], v[20:21]
  v_pk_fma_f32 v[150:151], v[150:151], v[30:31], v[22:23]
  v_pk_fma_f32 v[144:145], v[144:145], v[218:219], v[218:219] op_sel:[0,0,1] op_sel_hi:[1,0,1]
  v_pk_fma_f32 v[146:147], v[146:147], v[218:219], v[218:219] op_sel:[0,0,1] op_sel_hi:[1,0,1]
  v_pk_fma_f32 v[148:149], v[148:149], v[218:219], v[218:219] op_sel:[0,0,1] op_sel_hi:[1,0,1]
  v_pk_fma_f32 v[150:151], v[150:151], v[218:219], v[218:219] op_sel:[0,0,1] op_sel_hi:[1,0,1]
  v_cvt_pk_bf16_f32 v36, v144, v145
  v_cvt_pk_bf16_f32 v37, v146, v147
  v_cvt_pk_bf16_f32 v38, v148, v149
  v_cvt_pk_bf16_f32 v39, v150, v151
  ds_write_b128 v8, v[36:39] offset:36864
  s_add_u32 m0, s15, 12288
  s_mov_b32 s9, 86016
  buffer_load_dwordx4 v250, s[64:67], s9 offen offset:0 lds
  v_pk_fma_f32 v[152:153], v[152:153], v[24:25], v[16:17]
  v_pk_fma_f32 v[154:155], v[154:155], v[26:27], v[18:19]
  v_pk_fma_f32 v[156:157], v[156:157], v[28:29], v[20:21]
  v_pk_fma_f32 v[158:159], v[158:159], v[30:31], v[22:23]
  v_pk_fma_f32 v[152:153], v[152:153], v[220:221], v[220:221] op_sel:[0,0,1] op_sel_hi:[1,0,1]
  v_pk_fma_f32 v[154:155], v[154:155], v[220:221], v[220:221] op_sel:[0,0,1] op_sel_hi:[1,0,1]
  v_pk_fma_f32 v[156:157], v[156:157], v[220:221], v[220:221] op_sel:[0,0,1] op_sel_hi:[1,0,1]
  v_pk_fma_f32 v[158:159], v[158:159], v[220:221], v[220:221] op_sel:[0,0,1] op_sel_hi:[1,0,1]
  v_cvt_pk_bf16_f32 v40, v152, v153
  v_cvt_pk_bf16_f32 v41, v154, v155
  v_cvt_pk_bf16_f32 v42, v156, v157
  v_cvt_pk_bf16_f32 v43, v158, v159
  ds_write_b128 v8, v[40:43] offset:40960
  v_pk_fma_f32 v[160:161], v[160:161], v[24:25], v[16:17]
  v_pk_fma_f32 v[162:163], v[162:163], v[26:27], v[18:19]
  v_pk_fma_f32 v[164:165], v[164:165], v[28:29], v[20:21]
  v_pk_fma_f32 v[166:167], v[166:167], v[30:31], v[22:23]
  v_pk_fma_f32 v[160:161], v[160:161], v[222:223], v[222:223] op_sel:[0,0,1] op_sel_hi:[1,0,1]
  v_pk_fma_f32 v[162:163], v[162:163], v[222:223], v[222:223] op_sel:[0,0,1] op_sel_hi:[1,0,1]
  v_pk_fma_f32 v[164:165], v[164:165], v[222:223], v[222:223] op_sel:[0,0,1] op_sel_hi:[1,0,1]
  v_pk_fma_f32 v[166:167], v[166:167], v[222:223], v[222:223] op_sel:[0,0,1] op_sel_hi:[1,0,1]
  v_cvt_pk_bf16_f32 v44, v160, v161
  v_cvt_pk_bf16_f32 v45, v162, v163
  v_cvt_pk_bf16_f32 v46, v164, v165
  v_cvt_pk_bf16_f32 v47, v166, v167
  ds_write_b128 v8, v[44:47] offset:45056
  buffer_load_dwordx4 v251, s[64:67], s9 offen offset:1024 lds
  v_pk_fma_f32 v[168:169], v[168:169], v[24:25], v[16:17]
  v_pk_fma_f32 v[170:171], v[170:171], v[26:27], v[18:19]
  v_pk_fma_f32 v[172:173], v[172:173], v[28:29], v[20:21]
  v_pk_fma_f32 v[174:175], v[174:175], v[30:31], v[22:23]
  v_pk_fma_f32 v[168:169], v[168:169], v[224:225], v[224:225] op_sel:[0,0,1] op_sel_hi:[1,0,1]
  v_pk_fma_f32 v[170:171], v[170:171], v[224:225], v[224:225] op_sel:[0,0,1] op_sel_hi:[1,0,1]
  v_pk_fma_f32 v[172:173], v[172:173], v[224:225], v[224:225] op_sel:[0,0,1] op_sel_hi:[1,0,1]
  v_pk_fma_f32 v[174:175], v[174:175], v[224:225], v[224:225] op_sel:[0,0,1] op_sel_hi:[1,0,1]
  v_cvt_pk_bf16_f32 v32, v168, v169
  v_cvt_pk_bf16_f32 v33, v170, v171
  v_cvt_pk_bf16_f32 v34, v172, v173
  v_cvt_pk_bf16_f32 v35, v174, v175
  ds_write_b128 v8, v[32:35] offset:49152
  v_pk_fma_f32 v[176:177], v[176:177], v[24:25], v[16:17]
  v_pk_fma_f32 v[178:179], v[178:179], v[26:27], v[18:19]
  v_pk_fma_f32 v[180:181], v[180:181], v[28:29], v[20:21]
  v_pk_fma_f32 v[182:183], v[182:183], v[30:31], v[22:23]
  v_pk_fma_f32 v[176:177], v[176:177], v[226:227], v[226:227] op_sel:[0,0,1] op_sel_hi:[1,0,1]
  v_pk_fma_f32 v[178:179], v[178:179], v[226:227], v[226:227] op_sel:[0,0,1] op_sel_hi:[1,0,1]
  v_pk_fma_f32 v[180:181], v[180:181], v[226:227], v[226:227] op_sel:[0,0,1] op_sel_hi:[1,0,1]
  v_pk_fma_f32 v[182:183], v[182:183], v[226:227], v[226:227] op_sel:[0,0,1] op_sel_hi:[1,0,1]
  v_cvt_pk_bf16_f32 v36, v176, v177
  v_cvt_pk_bf16_f32 v37, v178, v179
  v_cvt_pk_bf16_f32 v38, v180, v181
  v_cvt_pk_bf16_f32 v39, v182, v183
  ds_write_b128 v8, v[36:39] offset:53248
  buffer_load_dwordx4 v252, s[64:67], s9 offen offset:2048 lds
  s_waitcnt lgkmcnt(0)
  s_barrier
  ds_read_b64_tr_b16 v[112:113], v12 offset:0
  ds_read_b64_tr_b16 v[114:115], v12 offset:1024
  ds_read_b64_tr_b16 v[116:117], v12 offset:2048
  ds_read_b64_tr_b16 v[118:119], v12 offset:3072
  ds_read_b64_tr_b16 v[120:121], v12 offset:4096
  ds_read_b64_tr_b16 v[122:123], v12 offset:5120
  ds_read_b64_tr_b16 v[124:125], v12 offset:6144
  ds_read_b64_tr_b16 v[126:127], v12 offset:7168
  ds_read_b64_tr_b16 v[128:129], v12 offset:8192
  ds_read_b64_tr_b16 v[130:131], v12 offset:9216
  ds_read_b64_tr_b16 v[132:133], v12 offset:10240
  ds_read_b64_tr_b16 v[134:135], v12 offset:11264
  s_waitcnt lgkmcnt(8)
  s_nop 0
  v_mfma_f32_32x32x16_bf16 v[16:31], a[0:3], v[112:115], 0
  ds_read_b64_tr_b16 v[136:137], v12 offset:12288
  ds_read_b64_tr_b16 v[138:139], v12 offset:13312
  buffer_load_dwordx4 v253, s[64:67], s9 offen offset:3072 lds
  v_mfma_f32_32x32x16_bf16 v[16:31], a[4:7], v[116:119], v[16:31]
  ds_read_b64_tr_b16 v[140:141], v12 offset:14336
  ds_read_b64_tr_b16 v[142:143], v12 offset:15360
  s_mul_i32 s10, s55, 229376
  s_lshl_b32 s7, s56, 14
  s_waitcnt lgkmcnt(8)
  v_mfma_f32_32x32x16_bf16 v[16:31], a[8:11], v[120:123], v[16:31]
  ds_read_b64_tr_b16 v[144:145], v12 offset:16384
  ds_read_b64_tr_b16 v[146:147], v12 offset:17408
  s_add_u32 m0, s15, 16384
  s_mov_b32 s9, 114688
  buffer_load_dwordx4 v250, s[64:67], s9 offen offset:0 lds
  v_mfma_f32_32x32x16_bf16 v[16:31], a[12:15], v[124:127], v[16:31]
  ds_read_b64_tr_b16 v[148:149], v12 offset:18432
  ds_read_b64_tr_b16 v[150:151], v12 offset:19456
  s_add_u32 s6, s10, s7
  s_lshl_b32 s7, s57, 12
  s_waitcnt lgkmcnt(8)
  v_mfma_f32_32x32x16_bf16 v[16:31], a[16:19], v[128:131], v[16:31]
  ds_read_b64_tr_b16 v[152:153], v12 offset:20480
  ds_read_b64_tr_b16 v[154:155], v12 offset:21504
  buffer_load_dwordx4 v251, s[64:67], s9 offen offset:1024 lds
  v_mfma_f32_32x32x16_bf16 v[16:31], a[20:23], v[132:135], v[16:31]
  ds_read_b64_tr_b16 v[156:157], v12 offset:22528
  ds_read_b64_tr_b16 v[158:159], v12 offset:23552
  s_add_u32 s6, s6, s7
  s_add_u32 s6, s6, 2621440
  s_waitcnt lgkmcnt(8)
  s_nop 0
  v_mfma_f32_32x32x16_bf16 v[16:31], a[24:27], v[136:139], v[16:31]
  ds_read_b64_tr_b16 v[160:161], v12 offset:24576
  ds_read_b64_tr_b16 v[162:163], v12 offset:25600
  buffer_load_dwordx4 v252, s[64:67], s9 offen offset:2048 lds
  v_mfma_f32_32x32x16_bf16 v[16:31], a[28:31], v[140:143], v[16:31]
  ds_read_b64_tr_b16 v[164:165], v12 offset:26624
  ds_read_b64_tr_b16 v[166:167], v12 offset:27648
  v_lshl_add_u32 v10, v1, 4, s6
  v_add_u32 v11, 114688, v10
  s_waitcnt lgkmcnt(8)
  v_mfma_f32_32x32x16_bf16 v[16:31], a[32:35], v[144:147], v[16:31]
  ds_read_b64_tr_b16 v[168:169], v12 offset:28672
  ds_read_b64_tr_b16 v[170:171], v12 offset:29696
  buffer_load_dwordx4 v253, s[64:67], s9 offen offset:3072 lds
  v_mfma_f32_32x32x16_bf16 v[16:31], a[36:39], v[148:151], v[16:31]
  ds_read_b64_tr_b16 v[172:173], v12 offset:30720
  ds_read_b64_tr_b16 v[174:175], v12 offset:31744
  s_lshl_b32 s6, s54, 2
  s_add_u32 s6, s6, s57
  s_waitcnt lgkmcnt(8)
  v_mfma_f32_32x32x16_bf16 v[16:31], a[40:43], v[152:155], v[16:31]
  ds_read_b64_tr_b16 v[176:177], v12 offset:32768
  ds_read_b64_tr_b16 v[178:179], v12 offset:33792
  s_add_u32 m0, s15, 20480
  s_mov_b32 s9, 143360
  buffer_load_dwordx4 v250, s[64:67], s9 offen offset:0 lds
  v_mfma_f32_32x32x16_bf16 v[16:31], a[44:47], v[156:159], v[16:31]
  ds_read_b64_tr_b16 v[180:181], v12 offset:34816
  ds_read_b64_tr_b16 v[182:183], v12 offset:35840
  s_lshl_b32 s6, s6, 6
  s_add_u32 s6, s6, 122880
  s_waitcnt lgkmcnt(8)
  v_mfma_f32_32x32x16_bf16 v[16:31], a[48:51], v[160:163], v[16:31]
  ds_read_b64_tr_b16 v[184:185], v12 offset:36864
  ds_read_b64_tr_b16 v[186:187], v12 offset:37888
  buffer_load_dwordx4 v251, s[64:67], s9 offen offset:1024 lds
  v_mfma_f32_32x32x16_bf16 v[16:31], a[52:55], v[164:167], v[16:31]
  ds_read_b64_tr_b16 v[188:189], v12 offset:38912
  ds_read_b64_tr_b16 v[190:191], v12 offset:39936
  v_mov_b32 v80, s6
  v_add_u32 v81, 57344, v80
  s_waitcnt lgkmcnt(8)
  v_mfma_f32_32x32x16_bf16 v[16:31], a[56:59], v[168:171], v[16:31]
  ds_read_b64_tr_b16 v[192:193], v12 offset:40960
  ds_read_b64_tr_b16 v[194:195], v12 offset:41984
  buffer_load_dwordx4 v252, s[64:67], s9 offen offset:2048 lds
  v_mfma_f32_32x32x16_bf16 v[16:31], a[60:63], v[172:175], v[16:31]
  ds_read_b64_tr_b16 v[196:197], v12 offset:43008
  ds_read_b64_tr_b16 v[198:199], v12 offset:44032
  s_mul_i32 s6, s55, 28
  s_mul_i32 s7, s57, 7
  s_waitcnt lgkmcnt(8)
  v_mfma_f32_32x32x16_bf16 v[16:31], a[64:67], v[176:179], v[16:31]
  ds_read_b64_tr_b16 v[200:201], v12 offset:45056
  ds_read_b64_tr_b16 v[202:203], v12 offset:46080
  buffer_load_dwordx4 v253, s[64:67], s9 offen offset:3072 lds
  v_mfma_f32_32x32x16_bf16 v[16:31], a[68:71], v[180:183], v[16:31]
  ds_read_b64_tr_b16 v[204:205], v12 offset:47104
  ds_read_b64_tr_b16 v[206:207], v12 offset:48128
  s_add_u32 s6, s6, s7
  s_lshl_b32 s6, s6, 6
  s_waitcnt lgkmcnt(8)
  v_mfma_f32_32x32x16_bf16 v[16:31], a[72:75], v[184:187], v[16:31]
  ds_read_b64_tr_b16 v[208:209], v12 offset:49152
  ds_read_b64_tr_b16 v[210:211], v12 offset:50176
  s_add_u32 s6, s6, 122880
  s_add_u32 s32, s48, s6
  s_addc_u32 s33, s49, 0
  v_mfma_f32_32x32x16_bf16 v[16:31], a[76:79], v[188:191], v[16:31]
  ds_read_b64_tr_b16 v[212:213], v12 offset:51200
  ds_read_b64_tr_b16 v[214:215], v12 offset:52224
  s_add_u32 s34, s32, 57344
  s_addc_u32 s35, s33, 0
  s_waitcnt lgkmcnt(8)
  v_mfma_f32_32x32x16_bf16 v[16:31], a[80:83], v[192:195], v[16:31]
  ds_read_b64_tr_b16 v[216:217], v12 offset:53248
  ds_read_b64_tr_b16 v[218:219], v12 offset:54272
  s_mul_i32 s7, s57, 28672
  s_add_u32 s6, s10, s7
  v_mfma_f32_32x32x16_bf16 v[16:31], a[84:87], v[196:199], v[16:31]
  ds_read_b64_tr_b16 v[220:221], v12 offset:55296
  ds_read_b64_tr_b16 v[222:223], v12 offset:56320
  s_add_u32 s6, s6, 2625536
  v_lshl_add_u32 v84, v1, 4, s6
  s_waitcnt lgkmcnt(8)
  v_mfma_f32_32x32x16_bf16 v[16:31], a[88:91], v[200:203], v[16:31]
  v_add_u32 v85, 8192, v84
  v_add_u32 v86, 16384, v84
  v_add_u32 v87, 24576, v84
  s_mul_i32 s6, s57, 401408
  s_mul_i32 s7, s53, 5120
  s_add_u32 s6, s6, s7
  v_mfma_f32_32x32x16_bf16 v[16:31], a[92:95], v[204:207], v[16:31]
  s_add_u32 s6, s6, 258048
  v_min_u32 v90, 39, v1
  v_lshl_add_u32 v90, v90, 7, s6
  global_load_dword v91, v90, s[38:39]
  s_waitcnt lgkmcnt(4)
  v_mfma_f32_32x32x16_bf16 v[16:31], a[96:99], v[208:211], v[16:31]
  v_mfma_f32_32x32x16_bf16 v[16:31], a[100:103], v[212:215], v[16:31]
  s_waitcnt lgkmcnt(0)
  v_mfma_f32_32x32x16_bf16 v[16:31], a[104:107], v[216:219], v[16:31]
  v_mfma_f32_32x32x16_bf16 v[16:31], a[108:111], v[220:223], v[16:31]
  v_mfma_f32_32x32x16_bf16 v[32:47], a[112:115], v[112:115], 0
  ds_read_b64_tr_b16 v[112:113], v13 offset:0
  ds_read_b64_tr_b16 v[114:115], v13 offset:1024
  v_mfma_f32_32x32x16_bf16 v[32:47], a[116:119], v[116:119], v[32:47]
  ds_read_b64_tr_b16 v[116:117], v13 offset:2048
  ds_read_b64_tr_b16 v[118:119], v13 offset:3072
  v_mfma_f32_32x32x16_bf16 v[32:47], a[120:123], v[120:123], v[32:47]
  ds_read_b64_tr_b16 v[120:121], v13 offset:4096
  ds_read_b64_tr_b16 v[122:123], v13 offset:5120
  v_mfma_f32_32x32x16_bf16 v[32:47], a[124:127], v[124:127], v[32:47]
  s_nop 1
  v_exp_f32 v48, -v16
  v_exp_f32 v49, -v17
  v_add_f32 v48, 1.0, v48
  v_exp_f32 v50, -v18
  v_mfma_f32_32x32x16_bf16 v[32:47], a[128:131], v[128:131], v[32:47]
  ds_read_b64_tr_b16 v[124:125], v13 offset:6144
  ds_read_b64_tr_b16 v[126:127], v13 offset:7168
  v_add_f32 v49, 1.0, v49
  v_rcp_f32 v48, v48
  v_mfma_f32_32x32x16_bf16 v[32:47], a[132:135], v[132:135], v[32:47]
  v_exp_f32 v51, -v19
  v_mul_f32 v48, v48, v16
  v_add_f32 v50, 1.0, v50
  v_rcp_f32_e64 v49, v49
  v_mfma_f32_32x32x16_bf16 v[32:47], a[136:139], v[136:139], v[32:47]
  ds_read_b64_tr_b16 v[128:129], v13 offset:8192
  ds_read_b64_tr_b16 v[130:131], v13 offset:9216
  v_exp_f32 v52, -v20
  v_mfma_f32_32x32x16_bf16 v[32:47], a[140:143], v[140:143], v[32:47]
  v_mul_f32 v49, v49, v17
  v_add_f32 v51, 1.0, v51
  v_rcp_f32_e64 v50, v50
  v_exp_f32 v53, -v21
  v_mfma_f32_32x32x16_bf16 v[32:47], a[144:147], v[144:147], v[32:47]
  ds_read_b64_tr_b16 v[132:133], v13 offset:10240
  ds_read_b64_tr_b16 v[134:135], v13 offset:11264
  v_mul_f32 v50, v50, v18
  v_add_f32 v52, 1.0, v52
  v_mfma_f32_32x32x16_bf16 v[32:47], a[148:151], v[148:151], v[32:47]
  v_rcp_f32 v51, v51
  v_cvt_pk_bf16_f32 v64, v48, v49
  v_exp_f32 v54, -v22
  v_mul_f32 v51, v51, v19
  v_mfma_f32_32x32x16_bf16 v[32:47], a[152:155], v[152:155], v[32:47]
  ds_read_b64_tr_b16 v[136:137], v13 offset:12288
  ds_read_b64_tr_b16 v[138:139], v13 offset:13312
  v_add_f32 v53, 1.0, v53
  v_rcp_f32 v52, v52
  v_mfma_f32_32x32x16_bf16 v[32:47], a[156:159], v[156:159], v[32:47]
  v_exp_f32 v55, -v23
  v_mul_f32 v52, v52, v20
  v_add_f32 v54, 1.0, v54
  v_rcp_f32_e64 v53, v53
  v_mfma_f32_32x32x16_bf16 v[32:47], a[160:163], v[160:163], v[32:47]
  ds_read_b64_tr_b16 v[140:141], v13 offset:14336
  ds_read_b64_tr_b16 v[142:143], v13 offset:15360
  v_cvt_pk_bf16_f32 v65, v50, v51
  v_exp_f32 v48, -v24
  v_mfma_f32_32x32x16_bf16 v[32:47], a[164:167], v[164:167], v[32:47]
  v_mul_f32 v53, v53, v21
  v_add_f32 v55, 1.0, v55
  v_rcp_f32_e64 v54, v54
  v_exp_f32 v49, -v25
  v_mfma_f32_32x32x16_bf16 v[32:47], a[168:171], v[168:171], v[32:47]
  ds_read_b64_tr_b16 v[144:145], v13 offset:16384
  ds_read_b64_tr_b16 v[146:147], v13 offset:17408
  v_mul_f32 v54, v54, v22
  v_add_f32 v48, 1.0, v48
  v_mfma_f32_32x32x16_bf16 v[32:47], a[172:175], v[172:175], v[32:47]
  v_rcp_f32 v55, v55
  v_cvt_pk_bf16_f32 v66, v52, v53
  v_exp_f32 v50, -v26
  v_mul_f32 v55, v55, v23
  v_mfma_f32_32x32x16_bf16 v[32:47], a[176:179], v[176:179], v[32:47]
  ds_read_b64_tr_b16 v[148:149], v13 offset:18432
  ds_read_b64_tr_b16 v[150:151], v13 offset:19456
  v_add_f32 v49, 1.0, v49
  v_rcp_f32 v48, v48
  v_mfma_f32_32x32x16_bf16 v[32:47], a[180:183], v[180:183], v[32:47]
  v_exp_f32 v51, -v27
  v_mul_f32 v48, v48, v24
  v_add_f32 v50, 1.0, v50
  v_rcp_f32_e64 v49, v49
  v_mfma_f32_32x32x16_bf16 v[32:47], a[184:187], v[184:187], v[32:47]
  ds_read_b64_tr_b16 v[152:153], v13 offset:20480
  ds_read_b64_tr_b16 v[154:155], v13 offset:21504
  v_cvt_pk_bf16_f32 v67, v54, v55
  global_store_dwordx4 v10, v[64:67], s[48:49] offset:0 sc1
  v_mfma_f32_32x32x16_bf16 v[32:47], a[188:191], v[188:191], v[32:47]
  v_exp_f32 v52, -v28
  v_mul_f32 v49, v49, v25
  v_add_f32 v51, 1.0, v51
  v_rcp_f32_e64 v50, v50
  v_mfma_f32_32x32x16_bf16 v[32:47], a[192:195], v[192:195], v[32:47]
  ds_read_b64_tr_b16 v[156:157], v13 offset:22528
  ds_read_b64_tr_b16 v[158:159], v13 offset:23552
  v_exp_f32 v53, -v29
  v_mfma_f32_32x32x16_bf16 v[32:47], a[196:199], v[196:199], v[32:47]
  v_mul_f32 v50, v50, v26
  v_add_f32 v52, 1.0, v52
  v_rcp_f32_e64 v51, v51
  v_cvt_pk_bf16_f32 v68, v48, v49
  v_exp_f32 v54, -v30
  v_mfma_f32_32x32x16_bf16 v[32:47], a[200:203], v[200:203], v[32:47]
  ds_read_b64_tr_b16 v[160:161], v13 offset:24576
  ds_read_b64_tr_b16 v[162:163], v13 offset:25600
  v_mul_f32 v51, v51, v27
  v_add_f32 v53, 1.0, v53
  v_mfma_f32_32x32x16_bf16 v[32:47], a[204:207], v[204:207], v[32:47]
  v_rcp_f32 v52, v52
  v_exp_f32 v55, -v31
  v_mul_f32 v52, v52, v28
  v_add_f32_e64 v54, 1.0, v54
  v_mfma_f32_32x32x16_bf16 v[32:47], a[208:211], v[208:211], v[32:47]
  ds_read_b64_tr_b16 v[164:165], v13 offset:26624
  ds_read_b64_tr_b16 v[166:167], v13 offset:27648
  v_rcp_f32 v53, v53
  v_mfma_f32_32x32x16_bf16 v[32:47], a[212:215], v[212:215], v[32:47]
  v_cvt_pk_bf16_f32 v69, v50, v51
  v_mul_f32 v53, v53, v29
  v_add_f32 v55, 1.0, v55
  v_rcp_f32 v54, v54
  s_nop 0
  v_mul_f32 v54, v54, v30
  v_mfma_f32_32x32x16_bf16 v[32:47], a[216:219], v[216:219], v[32:47]
  ds_read_b64_tr_b16 v[168:169], v13 offset:28672
  ds_read_b64_tr_b16 v[170:171], v13 offset:29696
  v_rcp_f32 v55, v55
  v_mfma_f32_32x32x16_bf16 v[32:47], a[220:223], v[220:223], v[32:47]
  v_cvt_pk_bf16_f32 v70, v52, v53
  v_mul_f32_e64 v55, v55, v31
  v_cvt_pk_bf16_f32 v71, v54, v55
  global_store_dwordx4 v10, v[68:71], s[48:49] offset:1024 sc1
  s_waitcnt lgkmcnt(14)
  v_mfma_f32_32x32x16_bf16 v[16:31], a[0:3], v[112:115], 0
  ds_read_b64_tr_b16 v[172:173], v13 offset:30720
  ds_read_b64_tr_b16 v[174:175], v13 offset:31744
  v_mfma_f32_32x32x16_bf16 v[16:31], a[4:7], v[116:119], v[16:31]
  ds_read_b64_tr_b16 v[176:177], v13 offset:32768
  ds_read_b64_tr_b16 v[178:179], v13 offset:33792
  v_mfma_f32_32x32x16_bf16 v[16:31], a[8:11], v[120:123], v[16:31]
  ds_read_b64_tr_b16 v[180:181], v13 offset:34816
  ds_read_b64_tr_b16 v[182:183], v13 offset:35840
  v_mfma_f32_32x32x16_bf16 v[16:31], a[12:15], v[124:127], v[16:31]
  ds_read_b64_tr_b16 v[184:185], v13 offset:36864
  ds_read_b64_tr_b16 v[186:187], v13 offset:37888
  v_exp_f32 v48, -v32
  v_mfma_f32_32x32x16_bf16 v[16:31], a[16:19], v[128:131], v[16:31]
  ds_read_b64_tr_b16 v[188:189], v13 offset:38912
  ds_read_b64_tr_b16 v[190:191], v13 offset:39936
  v_exp_f32 v49, -v33
  v_mfma_f32_32x32x16_bf16 v[16:31], a[20:23], v[132:135], v[16:31]
  ds_read_b64_tr_b16 v[192:193], v13 offset:40960
  ds_read_b64_tr_b16 v[194:195], v13 offset:41984
  v_add_f32_e64 v48, 1.0, v48
  v_exp_f32 v50, -v34
  v_mfma_f32_32x32x16_bf16 v[16:31], a[24:27], v[136:139], v[16:31]
  ds_read_b64_tr_b16 v[196:197], v13 offset:43008
  ds_read_b64_tr_b16 v[198:199], v13 offset:44032
  v_add_f32 v49, 1.0, v49
  v_rcp_f32 v48, v48
  v_mfma_f32_32x32x16_bf16 v[16:31], a[28:31], v[140:143], v[16:31]
  ds_read_b64_tr_b16 v[200:201], v13 offset:45056
  ds_read_b64_tr_b16 v[202:203], v13 offset:46080
  v_exp_f32 v51, -v35
  s_waitcnt lgkmcnt(14)
  v_mfma_f32_32x32x16_bf16 v[16:31], a[32:35], v[144:147], v[16:31]
  ds_read_b64_tr_b16 v[204:205], v13 offset:47104
  ds_read_b64_tr_b16 v[206:207], v13 offset:48128
  v_mul_f32 v48, v48, v32
  v_add_f32_e64 v50, 1.0, v50
  v_mfma_f32_32x32x16_bf16 v[16:31], a[36:39], v[148:151], v[16:31]
  ds_read_b64_tr_b16 v[208:209], v13 offset:49152
  ds_read_b64_tr_b16 v[210:211], v13 offset:50176
  v_rcp_f32_e64 v49, v49
  v_mfma_f32_32x32x16_bf16 v[16:31], a[40:43], v[152:155], v[16:31]
  ds_read_b64_tr_b16 v[212:213], v13 offset:51200
  ds_read_b64_tr_b16 v[214:215], v13 offset:52224
  v_exp_f32 v52, -v36
  v_mfma_f32_32x32x16_bf16 v[16:31], a[44:47], v[156:159], v[16:31]
  ds_read_b64_tr_b16 v[216:217], v13 offset:53248
  ds_read_b64_tr_b16 v[218:219], v13 offset:54272
  v_mul_f32 v49, v49, v33
  v_add_f32 v51, 1.0, v51
  v_mfma_f32_32x32x16_bf16 v[16:31], a[48:51], v[160:163], v[16:31]
  ds_read_b64_tr_b16 v[220:221], v13 offset:55296
  ds_read_b64_tr_b16 v[222:223], v13 offset:56320
  v_rcp_f32 v50, v50
  v_mfma_f32_32x32x16_bf16 v[16:31], a[52:55], v[164:167], v[16:31]
  v_exp_f32 v53, -v37
  v_mul_f32 v50, v50, v34
  v_add_f32 v52, 1.0, v52
  v_rcp_f32 v51, v51
  v_mfma_f32_32x32x16_bf16 v[16:31], a[56:59], v[168:171], v[16:31]
  v_cvt_pk_bf16_f32 v72, v48, v49
  v_exp_f32 v54, -v38
  v_mul_f32 v51, v51, v35
  v_add_f32 v53, 1.0, v53
  v_rcp_f32 v52, v52
  v_mfma_f32_32x32x16_bf16 v[16:31], a[60:63], v[172:175], v[16:31]
  v_exp_f32 v55, -v39
  v_mul_f32 v52, v52, v36
  v_add_f32 v54, 1.0, v54
  v_rcp_f32_e64 v53, v53
  s_waitcnt lgkmcnt(14)
  v_mfma_f32_32x32x16_bf16 v[16:31], a[64:67], v[176:179], v[16:31]
  v_cvt_pk_bf16_f32 v73, v50, v51
  v_exp_f32 v48, -v40
  v_mul_f32 v53, v53, v37
  v_add_f32 v55, 1.0, v55
  v_rcp_f32 v54, v54
  v_mfma_f32_32x32x16_bf16 v[16:31], a[68:71], v[180:183], v[16:31]
  v_exp_f32 v49, -v41
  v_mul_f32 v54, v54, v38
  v_add_f32 v48, 1.0, v48
  v_rcp_f32 v55, v55
  v_mfma_f32_32x32x16_bf16 v[16:31], a[72:75], v[184:187], v[16:31]
  v_cvt_pk_bf16_f32 v74, v52, v53
  v_exp_f32 v50, -v42
  v_mul_f32 v55, v55, v39
  v_add_f32 v49, 1.0, v49
  v_rcp_f32 v48, v48
  v_mfma_f32_32x32x16_bf16 v[16:31], a[76:79], v[188:191], v[16:31]
  v_exp_f32 v51, -v43
  v_mul_f32 v48, v48, v40
  v_add_f32 v50, 1.0, v50
  v_rcp_f32 v49, v49
  v_mfma_f32_32x32x16_bf16 v[16:31], a[80:83], v[192:195], v[16:31]
  v_cvt_pk_bf16_f32 v75, v54, v55
  global_store_dwordx4 v10, v[72:75], s[48:49] offset:2048 sc1
  v_exp_f32 v52, -v44
  v_mul_f32 v49, v49, v41
  v_add_f32 v51, 1.0, v51
  s_waitcnt lgkmcnt(12)
  v_mfma_f32_32x32x16_bf16 v[16:31], a[84:87], v[196:199], v[16:31]
  v_rcp_f32 v50, v50
  v_exp_f32 v53, -v45
  v_mul_f32 v50, v50, v42
  v_add_f32 v52, 1.0, v52
  s_waitcnt lgkmcnt(10)
  v_mfma_f32_32x32x16_bf16 v[16:31], a[88:91], v[200:203], v[16:31]
  v_rcp_f32 v51, v51
  v_cvt_pk_bf16_f32 v76, v48, v49
  v_exp_f32 v54, -v46
  v_mul_f32 v51, v51, v43
  s_waitcnt lgkmcnt(8)
  v_mfma_f32_32x32x16_bf16 v[16:31], a[92:95], v[204:207], v[16:31]
  v_add_f32 v53, 1.0, v53
  v_rcp_f32 v52, v52
  v_exp_f32 v55, -v47
  v_mul_f32 v52, v52, v44
  s_waitcnt lgkmcnt(6)
  v_mfma_f32_32x32x16_bf16 v[16:31], a[96:99], v[208:211], v[16:31]
  v_add_f32 v54, 1.0, v54
  v_rcp_f32 v53, v53
  v_cvt_pk_bf16_f32 v77, v50, v51
  v_mul_f32 v53, v53, v45
  v_add_f32 v55, 1.0, v55
  s_waitcnt lgkmcnt(4)
  v_mfma_f32_32x32x16_bf16 v[16:31], a[100:103], v[212:215], v[16:31]
  v_rcp_f32 v54, v54
  s_nop 0
  v_mul_f32 v54, v54, v46
  v_rcp_f32 v55, v55
  v_cvt_pk_bf16_f32 v78, v52, v53
  s_waitcnt lgkmcnt(2)
  v_mfma_f32_32x32x16_bf16 v[16:31], a[104:107], v[216:219], v[16:31]
  v_mul_f32_e64 v55, v55, v47
  v_cvt_pk_bf16_f32 v79, v54, v55
  global_store_dwordx4 v10, v[76:79], s[48:49] offset:3072 sc1
  s_waitcnt lgkmcnt(0)
  v_mfma_f32_32x32x16_bf16 v[16:31], a[108:111], v[220:223], v[16:31]
  s_barrier
  v_mfma_f32_32x32x16_bf16 v[32:47], a[112:115], v[112:115], 0
  s_mul_i32 s15, s57, 12288
  s_add_u32 s15, s15, 106496
  s_add_u32 m0, s15, 0
  s_nop 0
  s_mov_b32 s9, 172032
  buffer_load_dwordx4 v250, s[64:67], s9 offen offset:0 lds
  v_mfma_f32_32x32x16_bf16 v[32:47], a[116:119], v[116:119], v[32:47]
  buffer_load_dwordx4 v251, s[64:67], s9 offen offset:1024 lds
  v_mfma_f32_32x32x16_bf16 v[32:47], a[120:123], v[120:123], v[32:47]
  buffer_load_dwordx4 v252, s[64:67], s9 offen offset:2048 lds
  v_mfma_f32_32x32x16_bf16 v[32:47], a[124:127], v[124:127], v[32:47]
  buffer_load_dwordx4 v253, s[64:67], s9 offen offset:3072 lds
  v_exp_f32 v48, -v16
  v_exp_f32 v49, -v17
  v_add_f32 v48, 1.0, v48
  v_mfma_f32_32x32x16_bf16 v[32:47], a[128:131], v[128:131], v[32:47]
  v_exp_f32 v50, -v18
  v_add_f32 v49, 1.0, v49
  v_rcp_f32_e64 v48, v48
  v_exp_f32 v51, -v19
  v_mfma_f32_32x32x16_bf16 v[32:47], a[132:135], v[132:135], v[32:47]
  s_add_u32 m0, s15, 4096
  s_mov_b32 s9, 200704
  buffer_load_dwordx4 v250, s[64:67], s9 offen offset:0 lds
  v_mul_f32 v48, v48, v16
  v_add_f32 v50, 1.0, v50
  v_rcp_f32 v49, v49
  v_mfma_f32_32x32x16_bf16 v[32:47], a[136:139], v[136:139], v[32:47]
  v_exp_f32 v52, -v20
  v_mul_f32 v49, v49, v17
  v_add_f32 v51, 1.0, v51
  v_rcp_f32 v50, v50
  v_mfma_f32_32x32x16_bf16 v[32:47], a[140:143], v[140:143], v[32:47]
  buffer_load_dwordx4 v251, s[64:67], s9 offen offset:1024 lds
  v_exp_f32 v53, -v21
  v_mul_f32 v50, v50, v18
  v_add_f32 v52, 1.0, v52
  v_rcp_f32_e64 v51, v51
  v_mfma_f32_32x32x16_bf16 v[32:47], a[144:147], v[144:147], v[32:47]
  v_cvt_pk_bf16_f32 v64, v48, v49
  v_exp_f32 v54, -v22
  v_mul_f32 v51, v51, v19
  v_add_f32 v53, 1.0, v53
  v_rcp_f32_e64 v52, v52
  v_mfma_f32_32x32x16_bf16 v[32:47], a[148:151], v[148:151], v[32:47]
  buffer_load_dwordx4 v252, s[64:67], s9 offen offset:2048 lds
  v_exp_f32 v55, -v23
  v_mul_f32 v52, v52, v20
  v_add_f32 v54, 1.0, v54
  v_rcp_f32_e64 v53, v53
  v_mfma_f32_32x32x16_bf16 v[32:47], a[152:155], v[152:155], v[32:47]
  v_cvt_pk_bf16_f32 v65, v50, v51
  v_exp_f32 v48, -v24
  v_mul_f32 v53, v53, v21
  v_add_f32 v55, 1.0, v55
  v_rcp_f32_e64 v54, v54
  v_mfma_f32_32x32x16_bf16 v[32:47], a[156:159], v[156:159], v[32:47]
  buffer_load_dwordx4 v253, s[64:67], s9 offen offset:3072 lds
  v_exp_f32 v49, -v25
  v_mul_f32 v54, v54, v22
  v_add_f32 v48, 1.0, v48
  v_rcp_f32_e64 v55, v55
  v_mfma_f32_32x32x16_bf16 v[32:47], a[160:163], v[160:163], v[32:47]
  v_cvt_pk_bf16_f32 v66, v52, v53
  v_exp_f32 v50, -v26
  v_mul_f32 v55, v55, v23
  v_add_f32 v49, 1.0, v49
  v_rcp_f32_e64 v48, v48
  v_mfma_f32_32x32x16_bf16 v[32:47], a[164:167], v[164:167], v[32:47]
  s_add_u32 m0, s15, 8192
  s_mov_b32 s9, 229376
  buffer_load_dwordx4 v250, s[64:67], s9 offen offset:0 lds
  v_exp_f32 v51, -v27
  v_mul_f32 v48, v48, v24
  v_mfma_f32_32x32x16_bf16 v[32:47], a[168:171], v[168:171], v[32:47]
  v_add_f32 v50, 1.0, v50
  v_rcp_f32_e64 v49, v49
  v_cvt_pk_bf16_f32 v67, v54, v55
  global_store_dwordx4 v11, v[64:67], s[48:49] offset:0 sc1
  v_exp_f32 v52, -v28
  v_mfma_f32_32x32x16_bf16 v[32:47], a[172:175], v[172:175], v[32:47]
  buffer_load_dwordx4 v251, s[64:67], s9 offen offset:1024 lds
  v_mul_f32 v49, v49, v25
  v_add_f32 v51, 1.0, v51
  v_rcp_f32 v50, v50
  v_exp_f32 v53, -v29
  v_mfma_f32_32x32x16_bf16 v[32:47], a[176:179], v[176:179], v[32:47]
  v_mul_f32 v50, v50, v26
  v_add_f32 v52, 1.0, v52
  v_rcp_f32 v51, v51
  v_cvt_pk_bf16_f32 v68, v48, v49
  v_exp_f32 v54, -v30
  v_mfma_f32_32x32x16_bf16 v[32:47], a[180:183], v[180:183], v[32:47]
  buffer_load_dwordx4 v252, s[64:67], s9 offen offset:2048 lds
  v_mul_f32 v51, v51, v27
  v_add_f32 v53, 1.0, v53
  v_rcp_f32 v52, v52
  v_exp_f32 v55, -v31
  v_mfma_f32_32x32x16_bf16 v[32:47], a[184:187], v[184:187], v[32:47]
  v_mul_f32 v52, v52, v28
  v_add_f32 v54, 1.0, v54
  v_rcp_f32 v53, v53
  v_cvt_pk_bf16_f32 v69, v50, v51
  v_mul_f32 v53, v53, v29
  v_mfma_f32_32x32x16_bf16 v[32:47], a[188:191], v[188:191], v[32:47]
  buffer_load_dwordx4 v253, s[64:67], s9 offen offset:3072 lds
  v_add_f32 v55, 1.0, v55
  v_rcp_f32 v54, v54
  s_nop 0
  v_mul_f32 v54, v54, v30
  v_rcp_f32 v55, v55
  v_mfma_f32_32x32x16_bf16 v[32:47], a[192:195], v[192:195], v[32:47]
  v_cvt_pk_bf16_f32 v70, v52, v53
  v_mul_f32_e64 v55, v55, v31
  v_cvt_pk_bf16_f32 v71, v54, v55
  global_store_dwordx4 v11, v[68:71], s[48:49] offset:1024 sc1
  v_mfma_f32_32x32x16_bf16 v[32:47], a[196:199], v[196:199], v[32:47]
  v_mfma_f32_32x32x16_bf16 v[32:47], a[200:203], v[200:203], v[32:47]
  v_mfma_f32_32x32x16_bf16 v[32:47], a[204:207], v[204:207], v[32:47]
  v_mfma_f32_32x32x16_bf16 v[32:47], a[208:211], v[208:211], v[32:47]
  v_mfma_f32_32x32x16_bf16 v[32:47], a[212:215], v[212:215], v[32:47]
  v_mfma_f32_32x32x16_bf16 v[32:47], a[216:219], v[216:219], v[32:47]
  v_mfma_f32_32x32x16_bf16 v[32:47], a[220:223], v[220:223], v[32:47]
  s_waitcnt vmcnt(14)
  s_mov_b64 exec, 1
  global_store_dword v80, v239, s[48:49] sc1
  s_mov_b64 exec, -1
  s_nop 7
  v_exp_f32 v48, -v32
  v_exp_f32 v49, -v33
  v_add_f32 v48, 1.0, v48
  v_exp_f32 v50, -v34
  v_add_f32 v49, 1.0, v49
  v_rcp_f32 v48, v48
  v_exp_f32 v51, -v35
  v_mul_f32 v48, v48, v32
  v_add_f32 v50, 1.0, v50
  v_rcp_f32 v49, v49
  v_exp_f32 v52, -v36
  v_mul_f32 v49, v49, v33
  v_add_f32 v51, 1.0, v51
  v_rcp_f32 v50, v50
  v_exp_f32 v53, -v37
  v_mul_f32 v50, v50, v34
  v_add_f32 v52, 1.0, v52
  v_rcp_f32 v51, v51
  v_cvt_pk_bf16_f32 v72, v48, v49
  v_exp_f32 v54, -v38
  v_mul_f32 v51, v51, v35
  v_add_f32 v53, 1.0, v53
  v_rcp_f32 v52, v52
  v_exp_f32 v55, -v39
  v_mul_f32 v52, v52, v36
  v_add_f32 v54, 1.0, v54
  v_rcp_f32 v53, v53
  v_cvt_pk_bf16_f32 v73, v50, v51
  v_exp_f32 v48, -v40
  v_mul_f32 v53, v53, v37
  v_add_f32 v55, 1.0, v55
  v_rcp_f32 v54, v54
  v_exp_f32 v49, -v41
  v_mul_f32 v54, v54, v38
  v_add_f32 v48, 1.0, v48
  v_rcp_f32 v55, v55
  v_cvt_pk_bf16_f32 v74, v52, v53
  v_exp_f32 v50, -v42
  v_mul_f32 v55, v55, v39
  v_add_f32 v49, 1.0, v49
  v_rcp_f32 v48, v48
  v_exp_f32 v51, -v43
  v_mul_f32 v48, v48, v40
  v_add_f32 v50, 1.0, v50
  v_rcp_f32 v49, v49
  v_cvt_pk_bf16_f32 v75, v54, v55
  global_store_dwordx4 v11, v[72:75], s[48:49] offset:2048 sc1
  v_exp_f32 v52, -v44
  v_mul_f32 v49, v49, v41
  v_add_f32 v51, 1.0, v51
  v_rcp_f32 v50, v50
  v_exp_f32 v53, -v45
  v_mul_f32 v50, v50, v42
  v_add_f32 v52, 1.0, v52
  v_rcp_f32 v51, v51
  v_cvt_pk_bf16_f32 v76, v48, v49
  v_exp_f32 v54, -v46
  v_mul_f32 v51, v51, v43
  v_add_f32 v53, 1.0, v53
  v_rcp_f32 v52, v52
  v_exp_f32 v55, -v47
  v_mul_f32 v52, v52, v44
  v_add_f32 v54, 1.0, v54
  v_rcp_f32 v53, v53
  v_cvt_pk_bf16_f32 v77, v50, v51
  v_mul_f32 v53, v53, v45
  v_add_f32 v55, 1.0, v55
  v_rcp_f32 v54, v54
  s_nop 0
  v_mul_f32 v54, v54, v46
  v_rcp_f32 v55, v55
  v_cvt_pk_bf16_f32 v78, v52, v53
  v_mul_f32_e64 v55, v55, v47
  v_cvt_pk_bf16_f32 v79, v54, v55
  global_store_dwordx4 v11, v[76:79], s[48:49] offset:3072 sc1
  ds_read_b64_tr_b16 a[0:1], v242 offset:0
  ds_read_b64_tr_b16 a[2:3], v242 offset:1024
  ds_read_b64_tr_b16 a[4:5], v243 offset:0
  ds_read_b64_tr_b16 a[6:7], v243 offset:1024
  ds_read_b64_tr_b16 a[8:9], v242 offset:2048
  ds_read_b64_tr_b16 a[10:11], v242 offset:3072
  ds_read_b64_tr_b16 a[12:13], v243 offset:2048
  ds_read_b64_tr_b16 a[14:15], v243 offset:3072
  ds_read_b64_tr_b16 a[16:17], v242 offset:4096
  ds_read_b64_tr_b16 a[18:19], v242 offset:5120
  ds_read_b64_tr_b16 a[20:21], v243 offset:4096
  ds_read_b64_tr_b16 a[22:23], v243 offset:5120
  ds_read_b64_tr_b16 a[24:25], v242 offset:6144
  ds_read_b64_tr_b16 a[26:27], v242 offset:7168
  ds_read_b64_tr_b16 a[28:29], v243 offset:6144
  ds_read_b64_tr_b16 a[30:31], v243 offset:7168
  ds_read_b64_tr_b16 a[32:33], v242 offset:8192
  ds_read_b64_tr_b16 a[34:35], v242 offset:9216
  ds_read_b64_tr_b16 a[36:37], v243 offset:8192
  ds_read_b64_tr_b16 a[38:39], v243 offset:9216
  ds_read_b64_tr_b16 a[40:41], v242 offset:10240
  ds_read_b64_tr_b16 a[42:43], v242 offset:11264
  ds_read_b64_tr_b16 a[44:45], v243 offset:10240
  ds_read_b64_tr_b16 a[46:47], v243 offset:11264
  ds_write_b128 v8, v[228:231] offset:49152
  ds_write_b128 v8, v[232:235] offset:53248
  s_load_dword s18, s[32:33], 0 glc
  s_load_dword s19, s[32:33], 64 glc
  s_load_dword s20, s[32:33], 128 glc
  s_load_dword s21, s[32:33], 192 glc
  s_load_dword s22, s[32:33], 256 glc
  s_load_dword s23, s[32:33], 320 glc
  s_load_dword s24, s[32:33], 384 glc
  ds_read_b64_tr_b16 a[48:49], v242 offset:12288
  ds_read_b64_tr_b16 a[50:51], v242 offset:13312
  ds_read_b64_tr_b16 a[52:53], v243 offset:12288
  ds_read_b64_tr_b16 a[54:55], v243 offset:13312
  ds_read_b64_tr_b16 a[56:57], v242 offset:14336
  ds_read_b64_tr_b16 a[58:59], v242 offset:15360
  ds_read_b64_tr_b16 a[60:61], v243 offset:14336
  ds_read_b64_tr_b16 a[62:63], v243 offset:15360
  ds_read_b64_tr_b16 a[64:65], v242 offset:16384
  ds_read_b64_tr_b16 a[66:67], v242 offset:17408
  ds_read_b64_tr_b16 a[68:69], v243 offset:16384
  ds_read_b64_tr_b16 a[70:71], v243 offset:17408
  ds_read_b64_tr_b16 a[72:73], v242 offset:18432
  ds_read_b64_tr_b16 a[74:75], v242 offset:19456
  ds_read_b64_tr_b16 a[76:77], v243 offset:18432
  ds_read_b64_tr_b16 a[78:79], v243 offset:19456
  s_mov_b32 s8, 0
  s_waitcnt lgkmcnt(0)
  s_xor_b32 s18, s18, s50
  s_xor_b32 s19, s19, s50
  s_or_b32 s18, s18, s19
  s_xor_b32 s20, s20, s50
  s_or_b32 s18, s18, s20
  s_xor_b32 s21, s21, s50
  s_or_b32 s18, s18, s21
  s_xor_b32 s22, s22, s50
  s_or_b32 s18, s18, s22
  s_xor_b32 s23, s23, s50
  s_or_b32 s18, s18, s23
  s_xor_b32 s24, s24, s50
  s_or_b32 s18, s18, s24
  s_cbranch_scc0 L_poll2_done
L_poll2:
  s_sleep 4
  s_load_dword s18, s[32:33], 0 glc
  s_load_dword s19, s[32:33], 64 glc
  s_load_dword s20, s[32:33], 128 glc
  s_load_dword s21, s[32:33], 192 glc
  s_load_dword s22, s[32:33], 256 glc
  s_load_dword s23, s[32:33], 320 glc
  s_load_dword s24, s[32:33], 384 glc
  s_waitcnt lgkmcnt(0)
  s_xor_b32 s18, s18, s50
  s_xor_b32 s19, s19, s50
  s_or_b32 s18, s18, s19
  s_xor_b32 s20, s20, s50
  s_or_b32 s18, s18, s20
  s_xor_b32 s21, s21, s50
  s_or_b32 s18, s18, s21
  s_xor_b32 s22, s22, s50
  s_or_b32 s18, s18, s22
  s_xor_b32 s23, s23, s50
  s_or_b32 s18, s18, s23
  s_xor_b32 s24, s24, s50
  s_or_b32 s18, s18, s24
  s_cbranch_scc0 L_poll2_done
  s_add_u32 s8, s8, 1
  s_cmp_lt_u32 s8, 0x40000
  s_cbranch_scc1 L_poll2
L_poll2_done:
  global_load_dwordx4 v[112:115], v84, s[48:49] offset:-4096 sc1
  global_load_dwordx4 v[116:119], v84, s[48:49] offset:-3072 sc1
  global_load_dwordx4 v[120:123], v84, s[48:49] offset:-2048 sc1
  global_load_dwordx4 v[124:127], v84, s[48:49] offset:-1024 sc1
  global_load_dwordx4 v[128:131], v84, s[48:49] offset:0 sc1
  global_load_dwordx4 v[132:135], v84, s[48:49] offset:1024 sc1
  global_load_dwordx4 v[136:139], v84, s[48:49] offset:2048 sc1
  global_load_dwordx4 v[140:143], v84, s[48:49] offset:3072 sc1
  global_load_dwordx4 v[144:147], v85, s[48:49] offset:-4096 sc1
  global_load_dwordx4 v[148:151], v85, s[48:49] offset:-3072 sc1
  global_load_dwordx4 v[152:155], v85, s[48:49] offset:-2048 sc1
  global_load_dwordx4 v[156:159], v85, s[48:49] offset:-1024 sc1
  ds_read_b64_tr_b16 a[80:81], v242 offset:20480
  ds_read_b64_tr_b16 a[82:83], v242 offset:21504
  ds_read_b64_tr_b16 a[84:85], v243 offset:20480
  ds_read_b64_tr_b16 a[86:87], v243 offset:21504
  ds_read_b64_tr_b16 a[88:89], v242 offset:22528
  ds_read_b64_tr_b16 a[90:91], v242 offset:23552
  ds_read_b64_tr_b16 a[92:93], v243 offset:22528
  ds_read_b64_tr_b16 a[94:95], v243 offset:23552
  s_waitcnt vmcnt(16)
  s_nop 0
  ds_read_b64_tr_b16 a[96:97], v244 offset:0
  ds_read_b64_tr_b16 a[98:99], v244 offset:1024
  ds_read_b64_tr_b16 a[100:101], v245 offset:0
  ds_read_b64_tr_b16 a[102:103], v245 offset:1024
  ds_read_b64_tr_b16 a[104:105], v244 offset:2048
  ds_read_b64_tr_b16 a[106:107], v244 offset:3072
  ds_read_b64_tr_b16 a[108:109], v245 offset:2048
  ds_read_b64_tr_b16 a[110:111], v245 offset:3072
  s_waitcnt vmcnt(12)
  s_mov_b64 exec, 1
  global_store_dword v81, v239, s[48:49] sc1
  s_mov_b64 exec, -1
  s_waitcnt vmcnt(12)
  v_mfma_f32_32x32x16_bf16 v[16:31], a[0:3], v[112:115], 0
  s_mul_i32 s15, s57, 24576
  s_add_u32 s15, s15, 0
  s_add_u32 m0, s15, 0
  s_mov_b32 s9, 258048
  buffer_load_dwordx4 v250, s[64:67], s9 offen offset:0 lds
  v_mfma_f32_32x32x16_bf16 v[48:63], a[4:7], v[112:115], 0
  global_load_dwordx4 v[160:163], v85, s[48:49] offset:0 sc1
  buffer_load_dwordx4 v251, s[64:67], s9 offen offset:1024 lds
  ds_read_b64_tr_b16 a[112:113], v244 offset:4096
  ds_read_b64_tr_b16 a[114:115], v244 offset:5120
  s_waitcnt vmcnt(14)
  s_nop 0
  v_mfma_f32_32x32x16_bf16 v[16:31], a[8:11], v[116:119], v[16:31]
  buffer_load_dwordx4 v252, s[64:67], s9 offen offset:2048 lds
  ds_read_b64_tr_b16 a[116:117], v245 offset:4096
  ds_read_b64_tr_b16 a[118:119], v245 offset:5120
  v_mfma_f32_32x32x16_bf16 v[48:63], a[12:15], v[116:119], v[48:63]
  global_load_dwordx4 v[164:167], v85, s[48:49] offset:1024 sc1
  buffer_load_dwordx4 v253, s[64:67], s9 offen offset:3072 lds
  ds_read_b64_tr_b16 a[120:121], v244 offset:6144
  ds_read_b64_tr_b16 a[122:123], v244 offset:7168
  s_waitcnt vmcnt(16)
  s_nop 0
  v_mfma_f32_32x32x16_bf16 v[16:31], a[16:19], v[120:123], v[16:31]
  s_add_u32 m0, s15, 4096
  s_mov_b32 s9, 286720
  buffer_load_dwordx4 v250, s[64:67], s9 offen offset:0 lds
  ds_read_b64_tr_b16 a[124:125], v245 offset:6144
  v_mfma_f32_32x32x16_bf16 v[48:63], a[20:23], v[120:123], v[48:63]
  global_load_dwordx4 v[168:171], v85, s[48:49] offset:2048 sc1
  buffer_load_dwordx4 v251, s[64:67], s9 offen offset:1024 lds
  ds_read_b64_tr_b16 a[126:127], v245 offset:7168
  ds_read_b64_tr_b16 a[128:129], v244 offset:8192
  s_waitcnt vmcnt(18)
  s_nop 0
  v_mfma_f32_32x32x16_bf16 v[16:31], a[24:27], v[124:127], v[16:31]
  buffer_load_dwordx4 v252, s[64:67], s9 offen offset:2048 lds
  ds_read_b64_tr_b16 a[130:131], v244 offset:9216
  ds_read_b64_tr_b16 a[132:133], v245 offset:8192
  v_mfma_f32_32x32x16_bf16 v[48:63], a[28:31], v[124:127], v[48:63]
  global_load_dwordx4 v[172:175], v85, s[48:49] offset:3072 sc1
  buffer_load_dwordx4 v253, s[64:67], s9 offen offset:3072 lds
  ds_read_b64_tr_b16 a[134:135], v245 offset:9216
  ds_read_b64_tr_b16 a[136:137], v244 offset:10240
  s_waitcnt vmcnt(20)
  s_nop 0
  v_mfma_f32_32x32x16_bf16 v[16:31], a[32:35], v[128:131], v[16:31]
  s_add_u32 m0, s15, 8192
  s_mov_b32 s9, 315392
  buffer_load_dwordx4 v250, s[64:67], s9 offen offset:0 lds
  ds_read_b64_tr_b16 a[138:139], v244 offset:11264
  v_mfma_f32_32x32x16_bf16 v[48:63], a[36:39], v[128:131], v[48:63]
  global_load_dwordx4 v[176:179], v86, s[48:49] offset:-4096 sc1
  buffer_load_dwordx4 v251, s[64:67], s9 offen offset:1024 lds
  ds_read_b64_tr_b16 a[140:141], v245 offset:10240
  ds_read_b64_tr_b16 a[142:143], v245 offset:11264
  s_waitcnt vmcnt(22)
  s_nop 0
  v_mfma_f32_32x32x16_bf16 v[16:31], a[40:43], v[132:135], v[16:31]
  buffer_load_dwordx4 v252, s[64:67], s9 offen offset:2048 lds
  v_add_u32 v88, 114688, v84
  v_add_u32 v89, 114688, v85
  v_add_u32 v90, 114688, v86
  v_add_u32 v91, 114688, v87
  v_mfma_f32_32x32x16_bf16 v[48:63], a[44:47], v[132:135], v[48:63]
  global_load_dwordx4 v[180:183], v86, s[48:49] offset:-3072 sc1
  buffer_load_dwordx4 v253, s[64:67], s9 offen offset:3072 lds
  s_xor_b32 s6, s5, 0
  s_lshl_b32 s6, s6, 3
  s_add_u32 s6, s6, s57
  s_lshl_b32 s6, s6, 12
  s_waitcnt vmcnt(24)
  v_mfma_f32_32x32x16_bf16 v[16:31], a[48:51], v[136:139], v[16:31]
  s_add_u32 m0, s15, 12288
  s_mov_b32 s9, 344064
  buffer_load_dwordx4 v250, s[64:67], s9 offen offset:0 lds
  s_add_u32 s6, s6, 0
  v_lshl_add_u32 v4, v1, 4, s6
  v_mfma_f32_32x32x16_bf16 v[48:63], a[52:55], v[136:139], v[48:63]
  global_load_dwordx4 v[184:187], v86, s[48:49] offset:-2048 sc1
  buffer_load_dwordx4 v251, s[64:67], s9 offen offset:1024 lds
  s_xor_b32 s6, s5, 0
  s_lshl_b32 s6, s6, 3
  s_add_u32 s6, s6, s57
  s_lshl_b32 s6, s6, 12
  s_waitcnt vmcnt(26)
  v_mfma_f32_32x32x16_bf16 v[16:31], a[56:59], v[140:143], v[16:31]
  buffer_load_dwordx4 v252, s[64:67], s9 offen offset:2048 lds
  s_add_u32 s6, s6, 16384
  v_lshl_add_u32 v5, v1, 4, s6
  s_xor_b32 s6, s5, 1
  s_lshl_b32 s6, s6, 3
  v_mfma_f32_32x32x16_bf16 v[48:63], a[60:63], v[140:143], v[48:63]
  global_load_dwordx4 v[188:191], v86, s[48:49] offset:-1024 sc1
  buffer_load_dwordx4 v253, s[64:67], s9 offen offset:3072 lds
  s_add_u32 s6, s6, s57
  s_lshl_b32 s6, s6, 12
  s_add_u32 s6, s6, 0
  v_lshl_add_u32 v6, v1, 4, s6
  s_waitcnt vmcnt(28)
  v_mfma_f32_32x32x16_bf16 v[16:31], a[64:67], v[144:147], v[16:31]
  s_add_u32 m0, s15, 16384
  s_mov_b32 s9, 372736
  buffer_load_dwordx4 v250, s[64:67], s9 offen offset:0 lds
  s_xor_b32 s6, s5, 1
  s_lshl_b32 s6, s6, 3
  v_mfma_f32_32x32x16_bf16 v[48:63], a[68:71], v[144:147], v[48:63]
  global_load_dwordx4 v[192:195], v86, s[48:49] offset:0 sc1
  buffer_load_dwordx4 v251, s[64:67], s9 offen offset:1024 lds
  s_add_u32 s6, s6, s57
  s_lshl_b32 s6, s6, 12
  s_add_u32 s6, s6, 16384
  v_lshl_add_u32 v7, v1, 4, s6
  s_waitcnt vmcnt(30)
  v_mfma_f32_32x32x16_bf16 v[16:31], a[72:75], v[148:151], v[16:31]
  buffer_load_dwordx4 v252, s[64:67], s9 offen offset:2048 lds
  s_lshl_b32 s6, s57, 14
  v_lshl_add_u32 v9, v1, 4, s6
  s_lshl_b32 s7, s5, 7
  s_add_u32 s7, s7, 103936
  v_mfma_f32_32x32x16_bf16 v[48:63], a[76:79], v[148:151], v[48:63]
  global_load_dwordx4 v[196:199], v86, s[48:49] offset:1024 sc1
  buffer_load_dwordx4 v253, s[64:67], s9 offen offset:3072 lds
  v_lshrrev_b32 v14, 5, v1
  v_lshl_add_u32 v15, v14, 4, s7
  s_lshl_b32 s7, s3, 6
  v_xor_b32 v94, s7, v240
  s_waitcnt vmcnt(32) lgkmcnt(14)
  v_mfma_f32_32x32x16_bf16 v[16:31], a[80:83], v[152:155], v[16:31]
  s_lshl_b32 s7, s5, 12
  s_add_u32 s7, s7, 155648
  v_add_u32 v94, s7, v94
  s_lshl_b32 s10, s55, 6
  s_lshl_b32 s7, s3, 5
  v_mfma_f32_32x32x16_bf16 v[48:63], a[84:87], v[152:155], v[48:63]
  global_load_dwordx4 v[200:203], v86, s[48:49] offset:2048 sc1
  s_add_u32 s10, s10, s7
  s_mul_i32 s10, s10, 896
  s_lshl_b32 s7, s56, 7
  s_add_u32 s10, s10, s7
  s_lshl_b32 s7, s5, 6
  s_waitcnt vmcnt(32)
  v_mfma_f32_32x32x16_bf16 v[16:31], a[88:91], v[156:159], v[16:31]
  s_add_u32 s10, s10, s7
  v_and_b32 v95, 31, v1
  v_mul_u32_u24 v95, 896, v95
  v_lshl_add_u32 v95, v14, 4, v95
  v_add_u32 v95, s10, v95
  v_mfma_f32_32x32x16_bf16 v[48:63], a[92:95], v[156:159], v[48:63]
  global_load_dwordx4 v[204:207], v86, s[48:49] offset:3072 sc1
  s_load_dword s18, s[34:35], 0 glc
  s_load_dword s19, s[34:35], 64 glc
  s_load_dword s20, s[34:35], 128 glc
  s_load_dword s21, s[34:35], 192 glc
  s_load_dword s22, s[34:35], 256 glc
  s_load_dword s23, s[34:35], 320 glc
  s_load_dword s24, s[34:35], 384 glc
  s_waitcnt vmcnt(30)
  v_mfma_f32_32x32x16_bf16 v[16:31], a[96:99], v[160:163], v[16:31]
  v_mfma_f32_32x32x16_bf16 v[48:63], a[100:103], v[160:163], v[48:63]
  global_load_dwordx4 v[208:211], v87, s[48:49] offset:-4096 sc1
  s_waitcnt vmcnt(28)
  v_mfma_f32_32x32x16_bf16 v[16:31], a[104:107], v[164:167], v[16:31]
  v_mfma_f32_32x32x16_bf16 v[48:63], a[108:111], v[164:167], v[48:63]
  global_load_dwordx4 v[212:215], v87, s[48:49] offset:-3072 sc1
  s_waitcnt vmcnt(26)
  v_mfma_f32_32x32x16_bf16 v[16:31], a[112:115], v[168:171], v[16:31]
  s_waitcnt vmcnt(4)
  ds_read_b64_tr_b16 a[144:145], v242 offset:0
  ds_read_b64_tr_b16 a[146:147], v242 offset:1024
  ds_read_b64_tr_b16 a[148:149], v243 offset:0
  s_waitcnt lgkmcnt(0)
  s_nop 0
  v_mfma_f32_32x32x16_bf16 v[48:63], a[116:119], v[168:171], v[48:63]
  global_load_dwordx4 v[216:219], v87, s[48:49] offset:-2048 sc1
  ds_read_b64_tr_b16 a[150:151], v243 offset:1024
  ds_read_b64_tr_b16 a[152:153], v242 offset:2048
  ds_read_b64_tr_b16 a[154:155], v242 offset:3072
  v_mfma_f32_32x32x16_bf16 v[16:31], a[120:123], v[172:175], v[16:31]
  ds_read_b64_tr_b16 a[156:157], v243 offset:2048
  ds_read_b64_tr_b16 a[158:159], v243 offset:3072
  ds_read_b64_tr_b16 a[160:161], v242 offset:4096
  v_mfma_f32_32x32x16_bf16 v[48:63], a[124:127], v[172:175], v[48:63]
  global_load_dwordx4 v[220:223], v87, s[48:49] offset:-1024 sc1
  ds_read_b64_tr_b16 a[162:163], v242 offset:5120
  ds_read_b64_tr_b16 a[164:165], v243 offset:4096
  ds_read_b64_tr_b16 a[166:167], v243 offset:5120
  s_mov_b32 s8, 0
  s_xor_b32 s18, s18, s50
  s_xor_b32 s19, s19, s50
  s_or_b32 s18, s18, s19
  s_xor_b32 s20, s20, s50
  s_or_b32 s18, s18, s20
  s_xor_b32 s21, s21, s50
  s_or_b32 s18, s18, s21
  s_xor_b32 s22, s22, s50
  s_or_b32 s18, s18, s22
  s_xor_b32 s23, s23, s50
  s_or_b32 s18, s18, s23
  s_xor_b32 s24, s24, s50
  s_or_b32 s18, s18, s24
  s_cbranch_scc0 L_poll3_done
L_poll3:
  s_sleep 4
  s_load_dword s18, s[34:35], 0 glc
  s_load_dword s19, s[34:35], 64 glc
  s_load_dword s20, s[34:35], 128 glc
  s_load_dword s21, s[34:35], 192 glc
  s_load_dword s22, s[34:35], 256 glc
  s_load_dword s23, s[34:35], 320 glc
  s_load_dword s24, s[34:35], 384 glc
  s_waitcnt lgkmcnt(0)
  s_xor_b32 s18, s18, s50
  s_xor_b32 s19, s19, s50
  s_or_b32 s18, s18, s19
  s_xor_b32 s20, s20, s50
  s_or_b32 s18, s18, s20
  s_xor_b32 s21, s21, s50
  s_or_b32 s18, s18, s21
  s_xor_b32 s22, s22, s50
  s_or_b32 s18, s18, s22
  s_xor_b32 s23, s23, s50
  s_or_b32 s18, s18, s23
  s_xor_b32 s24, s24, s50
  s_or_b32 s18, s18, s24
  s_cbranch_scc0 L_poll3_done
  s_add_u32 s8, s8, 1
  s_cmp_lt_u32 s8, 0x40000
  s_cbranch_scc1 L_poll3
L_poll3_done:
  s_nop 0
  v_mfma_f32_32x32x16_bf16 v[16:31], a[128:131], v[176:179], v[16:31]
  ds_read_b64_tr_b16 a[168:169], v242 offset:6144
  ds_read_b64_tr_b16 a[170:171], v242 offset:7168
  ds_read_b64_tr_b16 a[172:173], v243 offset:6144
  v_mfma_f32_32x32x16_bf16 v[48:63], a[132:135], v[176:179], v[48:63]
  global_load_dwordx4 v[112:115], v88, s[48:49] offset:-4096 sc1
  ds_read_b64_tr_b16 a[174:175], v243 offset:7168
  ds_read_b64_tr_b16 a[176:177], v242 offset:8192
  ds_read_b64_tr_b16 a[178:179], v242 offset:9216
  v_mfma_f32_32x32x16_bf16 v[16:31], a[136:139], v[180:183], v[16:31]
  ds_read_b64_tr_b16 a[180:181], v243 offset:8192
  ds_read_b64_tr_b16 a[182:183], v243 offset:9216
  ds_read_b64_tr_b16 a[184:185], v242 offset:10240
  v_mfma_f32_32x32x16_bf16 v[48:63], a[140:143], v[180:183], v[48:63]
  global_load_dwordx4 v[116:119], v88, s[48:49] offset:-3072 sc1
  ds_read_b64_tr_b16 a[186:187], v242 offset:11264
  ds_read_b64_tr_b16 a[188:189], v243 offset:10240
  ds_read_b64_tr_b16 a[190:191], v243 offset:11264
  v_mfma_f32_32x32x16_bf16 v[16:31], a[144:147], v[184:187], v[16:31]
  ds_read_b64_tr_b16 a[192:193], v242 offset:12288
  ds_read_b64_tr_b16 a[194:195], v242 offset:13312
  ds_read_b64_tr_b16 a[196:197], v243 offset:12288
  s_waitcnt lgkmcnt(14)
  s_nop 0
  v_mfma_f32_32x32x16_bf16 v[48:63], a[148:151], v[184:187], v[48:63]
  global_load_dwordx4 v[120:123], v88, s[48:49] offset:-2048 sc1
  ds_read_b64_tr_b16 a[198:199], v243 offset:13312
  ds_read_b64_tr_b16 a[200:201], v242 offset:14336
  ds_read_b64_tr_b16 a[202:203], v242 offset:15360
  v_mfma_f32_32x32x16_bf16 v[16:31], a[152:155], v[188:191], v[16:31]
  ds_read_b64_tr_b16 a[204:205], v243 offset:14336
  ds_read_b64_tr_b16 a[206:207], v243 offset:15360
  ds_read_b64_tr_b16 a[208:209], v242 offset:16384
  v_mfma_f32_32x32x16_bf16 v[48:63], a[156:159], v[188:191], v[48:63]
  global_load_dwordx4 v[124:127], v88, s[48:49] offset:-1024 sc1
  ds_read_b64_tr_b16 a[210:211], v242 offset:17408
  ds_read_b64_tr_b16 a[212:213], v243 offset:16384
  ds_read_b64_tr_b16 a[214:215], v243 offset:17408
  v_mfma_f32_32x32x16_bf16 v[16:31], a[160:163], v[192:195], v[16:31]
  ds_read_b64_tr_b16 a[216:217], v242 offset:18432
  ds_read_b64_tr_b16 a[218:219], v242 offset:19456
  ds_read_b64_tr_b16 a[220:221], v243 offset:18432
  v_mfma_f32_32x32x16_bf16 v[48:63], a[164:167], v[192:195], v[48:63]
  global_load_dwordx4 v[128:131], v88, s[48:49] offset:0 sc1
  ds_read_b64_tr_b16 a[222:223], v243 offset:19456
  s_waitcnt lgkmcnt(14)
  v_mfma_f32_32x32x16_bf16 v[16:31], a[168:171], v[196:199], v[16:31]
  v_mfma_f32_32x32x16_bf16 v[48:63], a[172:175], v[196:199], v[48:63]
  global_load_dwordx4 v[132:135], v88, s[48:49] offset:1024 sc1
  s_waitcnt vmcnt(11)
  v_mfma_f32_32x32x16_bf16 v[16:31], a[176:179], v[200:203], v[16:31]
  v_mfma_f32_32x32x16_bf16 v[48:63], a[180:183], v[200:203], v[48:63]
  global_load_dwordx4 v[136:139], v88, s[48:49] offset:2048 sc1
  s_waitcnt vmcnt(11)
  v_mfma_f32_32x32x16_bf16 v[16:31], a[184:187], v[204:207], v[16:31]
  v_mfma_f32_32x32x16_bf16 v[48:63], a[188:191], v[204:207], v[48:63]
  global_load_dwordx4 v[140:143], v88, s[48:49] offset:3072 sc1
  s_waitcnt vmcnt(11)
  v_mfma_f32_32x32x16_bf16 v[16:31], a[192:195], v[208:211], v[16:31]
  s_waitcnt lgkmcnt(12)
  v_mfma_f32_32x32x16_bf16 v[48:63], a[196:199], v[208:211], v[48:63]
  global_load_dwordx4 v[144:147], v89, s[48:49] offset:-4096 sc1
  s_waitcnt vmcnt(11) lgkmcnt(10)
  v_mfma_f32_32x32x16_bf16 v[16:31], a[200:203], v[212:215], v[16:31]
  s_waitcnt lgkmcnt(8)
  v_mfma_f32_32x32x16_bf16 v[48:63], a[204:207], v[212:215], v[48:63]
  global_load_dwordx4 v[148:151], v89, s[48:49] offset:-3072 sc1
  s_waitcnt vmcnt(11) lgkmcnt(6)
  v_mfma_f32_32x32x16_bf16 v[16:31], a[208:211], v[216:219], v[16:31]
  s_waitcnt lgkmcnt(4)
  v_mfma_f32_32x32x16_bf16 v[48:63], a[212:215], v[216:219], v[48:63]
  global_load_dwordx4 v[152:155], v89, s[48:49] offset:-2048 sc1
  s_waitcnt vmcnt(11) lgkmcnt(2)
  v_mfma_f32_32x32x16_bf16 v[16:31], a[216:219], v[220:223], v[16:31]
  s_waitcnt lgkmcnt(0)
  v_mfma_f32_32x32x16_bf16 v[48:63], a[220:223], v[220:223], v[48:63]
  global_load_dwordx4 v[156:159], v89, s[48:49] offset:-1024 sc1
  s_barrier
  s_waitcnt vmcnt(11)
  v_mfma_f32_32x32x16_bf16 v[32:47], a[0:3], v[112:115], 0
  v_mfma_f32_32x32x16_bf16 v[64:79], a[4:7], v[112:115], 0
  global_load_dwordx4 v[160:163], v89, s[48:49] offset:0 sc1
  s_waitcnt vmcnt(11)
  v_mfma_f32_32x32x16_bf16 v[32:47], a[8:11], v[116:119], v[32:47]
  v_mfma_f32_32x32x16_bf16 v[64:79], a[12:15], v[116:119], v[64:79]
  global_load_dwordx4 v[164:167], v89, s[48:49] offset:1024 sc1
  s_waitcnt vmcnt(11)
  v_mfma_f32_32x32x16_bf16 v[32:47], a[16:19], v[120:123], v[32:47]
  ds_write_b128 v4, v[16:19] offset:0
  v_mfma_f32_32x32x16_bf16 v[64:79], a[20:23], v[120:123], v[64:79]
  global_load_dwordx4 v[168:171], v89, s[48:49] offset:2048 sc1
  ds_write_b128 v4, v[20:23] offset:1024
  s_waitcnt vmcnt(11)
  v_mfma_f32_32x32x16_bf16 v[32:47], a[24:27], v[124:127], v[32:47]
  ds_write_b128 v4, v[24:27] offset:2048
  v_mfma_f32_32x32x16_bf16 v[64:79], a[28:31], v[124:127], v[64:79]
  global_load_dwordx4 v[172:175], v89, s[48:49] offset:3072 sc1
  ds_write_b128 v4, v[28:31] offset:3072
  s_waitcnt vmcnt(11)
  v_mfma_f32_32x32x16_bf16 v[32:47], a[32:35], v[128:131], v[32:47]
  ds_write_b128 v6, v[48:51] offset:0
  v_mfma_f32_32x32x16_bf16 v[64:79], a[36:39], v[128:131], v[64:79]
  global_load_dwordx4 v[176:179], v90, s[48:49] offset:-4096 sc1
  ds_write_b128 v6, v[52:55] offset:1024
  s_waitcnt vmcnt(11)
  v_mfma_f32_32x32x16_bf16 v[32:47], a[40:43], v[132:135], v[32:47]
  ds_write_b128 v6, v[56:59] offset:2048
  v_mfma_f32_32x32x16_bf16 v[64:79], a[44:47], v[132:135], v[64:79]
  global_load_dwordx4 v[180:183], v90, s[48:49] offset:-3072 sc1
  ds_write_b128 v6, v[60:63] offset:3072
  s_waitcnt vmcnt(11)
  v_mfma_f32_32x32x16_bf16 v[32:47], a[48:51], v[136:139], v[32:47]
  ds_read_b128 v[96:99], v15 offset:0
  ds_read_b64_tr_b16 v[224:225], v94 offset:0
  v_mfma_f32_32x32x16_bf16 v[64:79], a[52:55], v[136:139], v[64:79]
  global_load_dwordx4 v[184:187], v90, s[48:49] offset:-2048 sc1
  ds_read_b128 v[100:103], v15 offset:32
  ds_read_b64_tr_b16 v[226:227], v94 offset:1024
  s_waitcnt vmcnt(11)
  v_mfma_f32_32x32x16_bf16 v[32:47], a[56:59], v[140:143], v[32:47]
  ds_read_b128 v[104:107], v15 offset:64
  ds_read_b64_tr_b16 v[228:229], v94 offset:2048
  v_mfma_f32_32x32x16_bf16 v[64:79], a[60:63], v[140:143], v[64:79]
  global_load_dwordx4 v[188:191], v90, s[48:49] offset:-1024 sc1
  ds_read_b128 v[108:111], v15 offset:96
  ds_read_b64_tr_b16 v[230:231], v94 offset:3072
  s_waitcnt vmcnt(11)
  v_mfma_f32_32x32x16_bf16 v[32:47], a[64:67], v[144:147], v[32:47]
  s_waitcnt lgkmcnt(6)
  v_lshlrev_b32 v16, 16, v224
  v_and_b32 v17, 0xffff0000, v224
  v_lshlrev_b32 v18, 16, v225
  v_and_b32 v19, 0xffff0000, v225
  v_mfma_f32_32x32x16_bf16 v[64:79], a[68:71], v[144:147], v[64:79]
  global_load_dwordx4 v[192:195], v90, s[48:49] offset:0 sc1
  s_waitcnt lgkmcnt(4)
  v_lshlrev_b32 v20, 16, v226
  v_and_b32 v21, 0xffff0000, v226
  v_lshlrev_b32 v22, 16, v227
  v_and_b32 v23, 0xffff0000, v227
  s_waitcnt vmcnt(11)
  v_mfma_f32_32x32x16_bf16 v[32:47], a[72:75], v[148:151], v[32:47]
  s_waitcnt lgkmcnt(2)
  v_lshlrev_b32 v24, 16, v228
  v_and_b32 v25, 0xffff0000, v228
  v_lshlrev_b32_e64 v26, 16, v229
  v_and_b32 v27, 0xffff0000, v229
  v_mfma_f32_32x32x16_bf16 v[64:79], a[76:79], v[148:151], v[64:79]
  global_load_dwordx4 v[196:199], v90, s[48:49] offset:1024 sc1
  s_waitcnt lgkmcnt(0)
  v_lshlrev_b32 v28, 16, v230
  v_and_b32 v29, 0xffff0000, v230
  v_lshlrev_b32 v30, 16, v231
  v_and_b32 v31, 0xffff0000, v231
  s_waitcnt vmcnt(11)
  v_mfma_f32_32x32x16_bf16 v[32:47], a[80:83], v[152:155], v[32:47]
  v_mfma_f32_32x32x16_bf16 v[64:79], a[84:87], v[152:155], v[64:79]
  global_load_dwordx4 v[200:203], v90, s[48:49] offset:2048 sc1
  s_waitcnt vmcnt(11)
  v_mfma_f32_32x32x16_bf16 v[32:47], a[88:91], v[156:159], v[32:47]
  v_mfma_f32_32x32x16_bf16 v[64:79], a[92:95], v[156:159], v[64:79]
  global_load_dwordx4 v[204:207], v90, s[48:49] offset:3072 sc1
  s_waitcnt vmcnt(11)
  v_mfma_f32_32x32x16_bf16 v[32:47], a[96:99], v[160:163], v[32:47]
  v_mfma_f32_32x32x16_bf16 v[64:79], a[100:103], v[160:163], v[64:79]
  global_load_dwordx4 v[208:211], v91, s[48:49] offset:-4096 sc1
  s_waitcnt vmcnt(11)
  v_mfma_f32_32x32x16_bf16 v[32:47], a[104:107], v[164:167], v[32:47]
  v_mfma_f32_32x32x16_bf16 v[64:79], a[108:111], v[164:167], v[64:79]
  global_load_dwordx4 v[212:215], v91, s[48:49] offset:-3072 sc1
  s_waitcnt vmcnt(11)
  v_mfma_f32_32x32x16_bf16 v[32:47], a[112:115], v[168:171], v[32:47]
  v_mfma_f32_32x32x16_bf16 v[64:79], a[116:119], v[168:171], v[64:79]
  global_load_dwordx4 v[216:219], v91, s[48:49] offset:-2048 sc1
  s_waitcnt vmcnt(11)
  v_mfma_f32_32x32x16_bf16 v[32:47], a[120:123], v[172:175], v[32:47]
  v_mfma_f32_32x32x16_bf16 v[64:79], a[124:127], v[172:175], v[64:79]
  global_load_dwordx4 v[220:223], v91, s[48:49] offset:-1024 sc1
  s_waitcnt vmcnt(11)
  v_mfma_f32_32x32x16_bf16 v[32:47], a[128:131], v[176:179], v[32:47]
  v_mfma_f32_32x32x16_bf16 v[64:79], a[132:135], v[176:179], v[64:79]
  s_waitcnt vmcnt(10)
  v_mfma_f32_32x32x16_bf16 v[32:47], a[136:139], v[180:183], v[32:47]
  v_mfma_f32_32x32x16_bf16 v[64:79], a[140:143], v[180:183], v[64:79]
  s_waitcnt vmcnt(9)
  v_mfma_f32_32x32x16_bf16 v[32:47], a[144:147], v[184:187], v[32:47]
  v_mfma_f32_32x32x16_bf16 v[64:79], a[148:151], v[184:187], v[64:79]
  s_waitcnt vmcnt(8)
  v_mfma_f32_32x32x16_bf16 v[32:47], a[152:155], v[188:191], v[32:47]
  v_mfma_f32_32x32x16_bf16 v[64:79], a[156:159], v[188:191], v[64:79]
  s_waitcnt vmcnt(7)
  v_mfma_f32_32x32x16_bf16 v[32:47], a[160:163], v[192:195], v[32:47]
  v_mfma_f32_32x32x16_bf16 v[64:79], a[164:167], v[192:195], v[64:79]
  s_waitcnt vmcnt(6)
  v_mfma_f32_32x32x16_bf16 v[32:47], a[168:171], v[196:199], v[32:47]
  v_mfma_f32_32x32x16_bf16 v[64:79], a[172:175], v[196:199], v[64:79]
  s_waitcnt vmcnt(5)
  v_mfma_f32_32x32x16_bf16 v[32:47], a[176:179], v[200:203], v[32:47]
  v_mfma_f32_32x32x16_bf16 v[64:79], a[180:183], v[200:203], v[64:79]
  s_waitcnt vmcnt(4)
  v_mfma_f32_32x32x16_bf16 v[32:47], a[184:187], v[204:207], v[32:47]
  v_mfma_f32_32x32x16_bf16 v[64:79], a[188:191], v[204:207], v[64:79]
  s_waitcnt vmcnt(3)
  v_mfma_f32_32x32x16_bf16 v[32:47], a[192:195], v[208:211], v[32:47]
  v_mfma_f32_32x32x16_bf16 v[64:79], a[196:199], v[208:211], v[64:79]
  s_waitcnt vmcnt(2)
  v_mfma_f32_32x32x16_bf16 v[32:47], a[200:203], v[212:215], v[32:47]
  v_mfma_f32_32x32x16_bf16 v[64:79], a[204:207], v[212:215], v[64:79]
  s_waitcnt vmcnt(1)
  v_mfma_f32_32x32x16_bf16 v[32:47], a[208:211], v[216:219], v[32:47]
  v_mfma_f32_32x32x16_bf16 v[64:79], a[212:215], v[216:219], v[64:79]
  s_waitcnt vmcnt(0)
  v_mfma_f32_32x32x16_bf16 v[32:47], a[216:219], v[220:223], v[32:47]
  v_mfma_f32_32x32x16_bf16 v[64:79], a[220:223], v[220:223], v[64:79]
  s_nop 11
  ds_write_b128 v7, v[64:67] offset:0
  ds_write_b128 v7, v[68:71] offset:1024
  ds_write_b128 v7, v[72:75] offset:2048
  ds_write_b128 v7, v[76:79] offset:3072
  ds_write_b128 v5, v[32:35] offset:0
  ds_write_b128 v5, v[36:39] offset:1024
  ds_write_b128 v5, v[40:43] offset:2048
  ds_write_b128 v5, v[44:47] offset:3072
  s_waitcnt lgkmcnt(0)
  s_barrier
  ds_read_b128 v[112:115], v9 offset:0
  ds_read_b128 v[116:119], v9 offset:1024
  ds_read_b128 v[120:123], v9 offset:2048
  ds_read_b128 v[124:127], v9 offset:3072
  ds_read_b128 v[128:131], v9 offset:4096
  ds_read_b128 v[132:135], v9 offset:5120
  ds_read_b128 v[136:139], v9 offset:6144
  ds_read_b128 v[140:143], v9 offset:7168
  ds_read_b128 v[144:147], v9 offset:8192
  ds_read_b128 v[148:151], v9 offset:9216
  ds_read_b128 v[152:155], v9 offset:10240
  ds_read_b128 v[156:159], v9 offset:11264
  ds_read_b128 v[160:163], v9 offset:12288
  ds_read_b128 v[164:167], v9 offset:13312
  ds_read_b128 v[168:171], v9 offset:14336
  ds_read_b128 v[172:175], v9 offset:15360
  s_waitcnt lgkmcnt(11)
  v_pk_add_f32 v[112:113], v[112:113], v[128:129]
  v_pk_add_f32 v[114:115], v[114:115], v[130:131]
  s_waitcnt lgkmcnt(10)
  v_pk_add_f32 v[116:117], v[116:117], v[132:133]
  v_pk_add_f32 v[118:119], v[118:119], v[134:135]
  s_waitcnt lgkmcnt(9)
  v_pk_add_f32 v[120:121], v[120:121], v[136:137]
  v_pk_add_f32 v[122:123], v[122:123], v[138:139]
  s_waitcnt lgkmcnt(8)
  v_pk_add_f32 v[124:125], v[124:125], v[140:141]
  v_pk_add_f32 v[126:127], v[126:127], v[142:143]
  s_waitcnt lgkmcnt(3)
  v_pk_add_f32 v[144:145], v[144:145], v[160:161]
  v_pk_add_f32 v[146:147], v[146:147], v[162:163]
  s_waitcnt lgkmcnt(2)
  v_pk_add_f32 v[148:149], v[148:149], v[164:165]
  v_pk_add_f32 v[150:151], v[150:151], v[166:167]
  s_waitcnt lgkmcnt(1)
  v_pk_add_f32 v[152:153], v[152:153], v[168:169]
  v_pk_add_f32 v[154:155], v[154:155], v[170:171]
  s_waitcnt lgkmcnt(0)
  v_pk_add_f32 v[156:157], v[156:157], v[172:173]
  v_pk_add_f32 v[158:159], v[158:159], v[174:175]
  v_pk_add_f32 v[112:113], v[112:113], v[144:145]
  v_pk_add_f32 v[114:115], v[114:115], v[146:147]
  v_pk_add_f32 v[116:117], v[116:117], v[148:149]
  v_pk_add_f32 v[118:119], v[118:119], v[150:151]
  v_pk_add_f32 v[120:121], v[120:121], v[152:153]
  v_pk_add_f32 v[122:123], v[122:123], v[154:155]
  v_pk_add_f32 v[124:125], v[124:125], v[156:157]
  v_pk_add_f32 v[126:127], v[126:127], v[158:159]
  v_pk_fma_f32 v[112:113], v[112:113], v[96:97], v[16:17]
  v_pk_fma_f32 v[114:115], v[114:115], v[98:99], v[18:19]
  v_pk_fma_f32 v[116:117], v[116:117], v[100:101], v[20:21]
  v_pk_fma_f32 v[118:119], v[118:119], v[102:103], v[22:23]
  v_pk_fma_f32 v[120:121], v[120:121], v[104:105], v[24:25]
  v_pk_fma_f32 v[122:123], v[122:123], v[106:107], v[26:27]
  v_pk_fma_f32 v[124:125], v[124:125], v[108:109], v[28:29]
  v_pk_fma_f32 v[126:127], v[126:127], v[110:111], v[30:31]
  v_cvt_pk_bf16_f32 v176, v112, v113
  v_cvt_pk_bf16_f32 v177, v114, v115
  v_cvt_pk_bf16_f32 v178, v116, v117
  v_cvt_pk_bf16_f32 v179, v118, v119
  v_cvt_pk_bf16_f32 v180, v120, v121
  v_cvt_pk_bf16_f32 v181, v122, v123
  v_cvt_pk_bf16_f32 v182, v124, v125
  v_cvt_pk_bf16_f32 v183, v126, v127
  v_permlane32_swap_b32 v176, v178
  v_permlane32_swap_b32 v177, v179
  v_permlane32_swap_b32 v180, v182
  v_permlane32_swap_b32 v181, v183
  global_store_dwordx4 v95, v[176:179], s[44:45] offset:0
  global_store_dwordx4 v95, v[180:183], s[44:45] offset:32
L_end:
  s_endpgm
L_spare:
  s_sub_u32 s12, s53, 28
  s_lshl_b32 s10, s12, 3
  s_add_u32 s10, s10, s52
  v_min_u32 v24, 223, v0
  v_lshlrev_b32 v24, 2, v24
  s_waitcnt lgkmcnt(0)
  global_load_dword v25, v24, s[40:41]
  s_load_dword s51, s[48:49], 0
  s_cmp_ge_u32 s10, 28
  s_cbranch_scc1 L_spare_idle
  v_lshrrev_b32 v29, 3, v1
  v_mul_u32_u24 v26, 7, v29
  s_and_b32 s13, s10, 1
  s_mul_i32 s11, s13, 224
  s_mul_i32 s14, s57, 56
  s_add_u32 s11, s11, s14
  v_add_u32 v26, s11, v26
  v_mul_u32_u24 v27, 5376, v26
  v_and_b32 v28, 7, v1
  v_lshlrev_b32 v28, 4, v28
  s_lshr_b32 s11, s10, 1
  s_lshl_b32 s11, s11, 7
  v_add3_u32 v27, v27, v28, s11
  global_load_dwordx4 v[64:67], v27, s[42:43]
  v_add_u32 v27, 5376, v27
  global_load_dwordx4 v[68:71], v27, s[42:43]
  v_add_u32 v27, 5376, v27
  global_load_dwordx4 v[72:75], v27, s[42:43]
  v_add_u32 v27, 5376, v27
  global_load_dwordx4 v[76:79], v27, s[42:43]
  v_add_u32 v27, 5376, v27
  global_load_dwordx4 v[80:83], v27, s[42:43]
  v_add_u32 v27, 5376, v27
  global_load_dwordx4 v[84:87], v27, s[42:43]
  v_add_u32 v27, 5376, v27
  global_load_dwordx4 v[88:91], v27, s[42:43]
  s_cmp_eq_u32 s3, 0
  s_cbranch_scc1 L_sp_ld
  s_lshl_b32 s4, s2, 3
  s_lshl_b32 s6, s5, 2
  s_add_u32 s4, s4, s6
  s_mul_i32 s6, s4, 896
  v_lshrrev_b32 v2, 5, v1
  v_mul_u32_u24 v2, 768, v2
  v_lshl_add_u32 v3, v1, 5, s6
  v_add_u32 v3, v2, v3
  v_mov_b32 v4, 0
  v_mov_b32 v5, 0
  v_mov_b32 v6, 0
  v_mov_b32 v7, 0
  v_mov_b32 v8, 0
  v_mov_b32 v9, 0
  v_mov_b32 v10, 0
  v_mov_b32 v11, 0
  v_mov_b32 v12, 0
  v_mov_b32 v13, 0
  v_mov_b32 v14, 0
  v_mov_b32 v15, 0
  v_mov_b32 v16, 0
  v_mov_b32 v17, 0
  v_mov_b32 v18, 0
  v_mov_b32_e64 v19, 0
  s_mov_b32 exec_lo, 0x0fffffff
  s_mov_b32 exec_hi, 0x0fffffff
  global_load_dwordx4 v[4:7], v3, s[16:17]
  global_load_dwordx4 v[8:11], v3, s[16:17] offset:16
  global_load_dwordx4 v[12:15], v3, s[16:17] offset:896
  global_load_dwordx4 v[16:19], v3, s[16:17] offset:912
  s_mov_b64 exec, -1
L_sp_ld:
  v_mul_u32_u24 v30, 14, v29
  s_mul_i32 s11, s57, 112
  v_add_u32 v30, s11, v30
  v_mul_u32_u24 v31, 5376, v30
  s_lshl_b32 s11, s10, 7
  s_add_u32 s11, s11, 1792
  v_add3_u32 v31, v31, v28, s11
  v_lshlrev_b32 v26, 2, v26
  v_lshlrev_b32 v30, 2, v30
  v_lshrrev_b32 v29, 3, v0
  v_lshlrev_b32 v29, 8, v29
  v_lshl_add_u32 v29, v28, 1, v29
  v_and_b32 v200, 31, v1
  v_lshlrev_b32 v201, 3, v200
  v_lshrrev_b32 v202, 5, v1
  v_lshl_add_u32 v202, v202, 12, v201
  s_waitcnt vmcnt(7)
  v_lshlrev_b32 v34, 16, v25
  v_and_b32 v35, 0xffff0000, v25
  s_mov_b32 s8, 0xbfb8aa3b
  v_mul_f32 v32, s8, v34
  v_mul_f32 v33, s8, v35
  v_exp_f32 v32, v32
  v_exp_f32 v33, v33
  v_add_f32 v32, 1.0, v32
  v_add_f32 v33, 1.0, v33
  v_rcp_f32 v32, v32
  v_rcp_f32 v33, v33
  v_mul_f32 v34, v34, v32
  v_mul_f32 v35, v35, v33
  v_cvt_pk_bf16_f32 v34, v34, v35
  v_and_b32 v32, 0xffff, v34
  v_lshrrev_b32 v33, 16, v34
  v_lshlrev_b32 v24, 1, v24
  ds_write_b64 v24, v[32:33]
  s_waitcnt lgkmcnt(0)
  s_add_u32 s51, s51, 1
  s_mul_i32 s50, s51, 0x9E3779B1
  s_add_u32 s50, s50, 0x7F4A7C15
  s_barrier
  ds_read_b32 v34, v26 offset:0
  ds_read_b32 v35, v26 offset:4
  ds_read_b32 v36, v26 offset:8
  ds_read_b32 v37, v26 offset:12
  ds_read_b32 v38, v26 offset:16
  ds_read_b32 v39, v26 offset:20
  ds_read_b32 v40, v26 offset:24
  s_waitcnt lgkmcnt(6)
  v_lshlrev_b32 v48, 16, v34
  s_waitcnt lgkmcnt(5)
  v_lshlrev_b32 v49, 16, v35
  s_waitcnt lgkmcnt(4)
  v_lshlrev_b32 v50, 16, v36
  s_waitcnt lgkmcnt(3)
  v_lshlrev_b32 v51, 16, v37
  s_waitcnt lgkmcnt(2)
  v_lshlrev_b32 v52, 16, v38
  s_waitcnt lgkmcnt(1)
  v_lshlrev_b32 v53, 16, v39
  s_waitcnt lgkmcnt(0)
  v_lshlrev_b32_e64 v54, 16, v40
  s_waitcnt vmcnt(6)
  v_dot2_f32_bf16 v176, v64, v34, 0
  v_dot2_f32_bf16 v177, v64, v48, 0
  v_dot2_f32_bf16 v178, v65, v34, 0
  v_dot2_f32_bf16 v179, v65, v48, 0
  v_dot2_f32_bf16 v180, v66, v34, 0
  v_dot2_f32_bf16 v181, v66, v48, 0
  v_dot2_f32_bf16 v182, v67, v34, 0
  v_dot2_f32_bf16 v183, v67, v48, 0
  s_waitcnt vmcnt(5)
  s_nop 0
  v_dot2_f32_bf16 v176, v68, v35, v176
  v_dot2_f32_bf16 v177, v68, v49, v177
  v_dot2_f32_bf16 v178, v69, v35, v178
  v_dot2_f32_bf16 v179, v69, v49, v179
  v_dot2_f32_bf16 v180, v70, v35, v180
  v_dot2_f32_bf16 v181, v70, v49, v181
  v_dot2_f32_bf16 v182, v71, v35, v182
  v_dot2_f32_bf16 v183, v71, v49, v183
  s_waitcnt vmcnt(4)
  s_nop 0
  v_dot2_f32_bf16 v176, v72, v36, v176
  v_dot2_f32_bf16 v177, v72, v50, v177
  v_dot2_f32_bf16 v178, v73, v36, v178
  v_dot2_f32_bf16 v179, v73, v50, v179
  v_dot2_f32_bf16 v180, v74, v36, v180
  v_dot2_f32_bf16 v181, v74, v50, v181
  v_dot2_f32_bf16 v182, v75, v36, v182
  v_dot2_f32_bf16 v183, v75, v50, v183
  s_waitcnt vmcnt(3)
  s_nop 0
  v_dot2_f32_bf16 v176, v76, v37, v176
  v_dot2_f32_bf16 v177, v76, v51, v177
  v_dot2_f32_bf16 v178, v77, v37, v178
  v_dot2_f32_bf16 v179, v77, v51, v179
  v_dot2_f32_bf16 v180, v78, v37, v180
  v_dot2_f32_bf16 v181, v78, v51, v181
  v_dot2_f32_bf16 v182, v79, v37, v182
  v_dot2_f32_bf16 v183, v79, v51, v183
  s_waitcnt vmcnt(2)
  s_nop 0
  v_dot2_f32_bf16 v176, v80, v38, v176
  v_dot2_f32_bf16 v177, v80, v52, v177
  v_dot2_f32_bf16 v178, v81, v38, v178
  v_dot2_f32_bf16 v179, v81, v52, v179
  v_dot2_f32_bf16 v180, v82, v38, v180
  v_dot2_f32_bf16 v181, v82, v52, v181
  v_dot2_f32_bf16 v182, v83, v38, v182
  v_dot2_f32_bf16 v183, v83, v52, v183
  s_waitcnt vmcnt(1)
  s_nop 0
  v_dot2_f32_bf16 v176, v84, v39, v176
  v_dot2_f32_bf16 v177, v84, v53, v177
  v_dot2_f32_bf16 v178, v85, v39, v178
  v_dot2_f32_bf16 v179, v85, v53, v179
  v_dot2_f32_bf16 v180, v86, v39, v180
  v_dot2_f32_bf16 v181, v86, v53, v181
  v_dot2_f32_bf16 v182, v87, v39, v182
  v_dot2_f32_bf16 v183, v87, v53, v183
  s_waitcnt vmcnt(0)
  s_nop 0
  v_dot2_f32_bf16 v176, v88, v40, v176
  v_dot2_f32_bf16 v177, v88, v54, v177
  v_dot2_f32_bf16 v178, v89, v40, v178
  v_dot2_f32_bf16 v179, v89, v54, v179
  v_dot2_f32_bf16 v180, v90, v40, v180
  v_dot2_f32_bf16 v181, v90, v54, v181
  v_dot2_f32_bf16 v182, v91, v40, v182
  v_dot2_f32_bf16 v183, v91, v54, v183
  ds_write_b128 v29, v[176:179] offset:2048
  ds_write_b128 v29, v[180:183] offset:2064
  s_waitcnt lgkmcnt(0)
  s_barrier
  s_cmp_lg_u32 s57, 0
  s_cbranch_scc1 L_spare_red0
  ds_read_b64 v[204:205], v202 offset:2048
  ds_read_b64 v[206:207], v202 offset:2304
  ds_read_b64 v[208:209], v202 offset:2560
  ds_read_b64 v[210:211], v202 offset:2816
  ds_read_b64 v[212:213], v202 offset:3072
  ds_read_b64 v[214:215], v202 offset:3328
  ds_read_b64 v[216:217], v202 offset:3584
  ds_read_b64 v[218:219], v202 offset:3840
  ds_read_b64 v[220:221], v202 offset:4096
  ds_read_b64 v[222:223], v202 offset:4352
  ds_read_b64 v[224:225], v202 offset:4608
  ds_read_b64 v[226:227], v202 offset:4864
  ds_read_b64 v[228:229], v202 offset:5120
  ds_read_b64 v[230:231], v202 offset:5376
  ds_read_b64 v[232:233], v202 offset:5632
  ds_read_b64 v[234:235], v202 offset:5888
  s_waitcnt lgkmcnt(14)
  v_pk_add_f32 v[204:205], v[204:205], v[206:207]
  s_waitcnt lgkmcnt(13)
  v_pk_add_f32 v[204:205], v[204:205], v[208:209]
  s_waitcnt lgkmcnt(12)
  v_pk_add_f32 v[204:205], v[204:205], v[210:211]
  s_waitcnt lgkmcnt(11)
  v_pk_add_f32 v[204:205], v[204:205], v[212:213]
  s_waitcnt lgkmcnt(10)
  v_pk_add_f32 v[204:205], v[204:205], v[214:215]
  s_waitcnt lgkmcnt(9)
  v_pk_add_f32 v[204:205], v[204:205], v[216:217]
  s_waitcnt lgkmcnt(8)
  v_pk_add_f32 v[204:205], v[204:205], v[218:219]
  s_waitcnt lgkmcnt(7)
  v_pk_add_f32 v[204:205], v[204:205], v[220:221]
  s_waitcnt lgkmcnt(6)
  v_pk_add_f32 v[204:205], v[204:205], v[222:223]
  s_waitcnt lgkmcnt(5)
  v_pk_add_f32 v[204:205], v[204:205], v[224:225]
  s_waitcnt lgkmcnt(4)
  v_pk_add_f32 v[204:205], v[204:205], v[226:227]
  s_waitcnt lgkmcnt(3)
  v_pk_add_f32 v[204:205], v[204:205], v[228:229]
  s_waitcnt lgkmcnt(2)
  v_pk_add_f32 v[204:205], v[204:205], v[230:231]
  s_waitcnt lgkmcnt(1)
  v_pk_add_f32 v[204:205], v[204:205], v[232:233]
  s_waitcnt lgkmcnt(0)
  v_pk_add_f32 v[204:205], v[204:205], v[234:235]
  v_mov_b32 v206, v204
  v_mov_b32 v207, v205
  s_nop 0
  v_permlane32_swap_b32 v204, v206
  v_permlane32_swap_b32 v205, v207
  v_pk_add_f32 v[204:205], v[204:205], v[206:207]
  v_mov_b32 v206, s50
  v_mov_b32 v207, s50
  s_mul_i32 s11, s13, 7168
  s_lshr_b32 s14, s10, 1
  s_lshl_b32 s14, s14, 9
  s_add_u32 s11, s11, s14
  s_add_u32 s11, s11, 4096
  v_lshl_add_u32 v203, v200, 4, s11
  s_mov_b32 exec_hi, 0
  global_store_dwordx4 v203, v[204:207], s[48:49] sc1
  s_mov_b32 exec_hi, -1
L_spare_red0:
  s_cmp_eq_u32 s3, 0
  s_cbranch_scc1 L_sp_st
  s_waitcnt vmcnt(0)
  v_mov_b32 v2, 0x3f803f80
  v_dot2_f32_bf16 v20, v4, v2, 0
  v_dot2_f32_bf16 v21, v4, v4, 0
  v_dot2_f32_bf16 v22, v12, v2, 0
  v_dot2_f32_bf16 v23, v12, v12, 0
  v_dot2_f32_bf16 v20, v5, v2, v20
  v_dot2_f32_bf16 v21, v5, v5, v21
  v_dot2_f32_bf16 v22, v13, v2, v22
  v_dot2_f32_bf16 v23, v13, v13, v23
  v_dot2_f32_bf16 v20, v6, v2, v20
  v_dot2_f32_bf16 v21, v6, v6, v21
  v_dot2_f32_bf16 v22, v14, v2, v22
  v_dot2_f32_bf16 v23, v14, v14, v23
  v_dot2_f32_bf16 v20, v7, v2, v20
  v_dot2_f32_bf16 v21, v7, v7, v21
  v_dot2_f32_bf16 v22, v15, v2, v22
  v_dot2_f32_bf16 v23, v15, v15, v23
  v_dot2_f32_bf16 v20, v8, v2, v20
  v_dot2_f32_bf16 v21, v8, v8, v21
  v_dot2_f32_bf16 v22, v16, v2, v22
  v_dot2_f32_bf16 v23, v16, v16, v23
  v_dot2_f32_bf16 v20, v9, v2, v20
  v_dot2_f32_bf16 v21, v9, v9, v21
  v_dot2_f32_bf16 v22, v17, v2, v22
  v_dot2_f32_bf16 v23, v17, v17, v23
  v_dot2_f32_bf16 v20, v10, v2, v20
  v_dot2_f32_bf16 v21, v10, v10, v21
  v_dot2_f32_bf16 v22, v18, v2, v22
  v_dot2_f32_bf16 v23, v18, v18, v23
  v_dot2_f32_bf16 v20, v11, v2, v20
  v_dot2_f32_bf16 v21, v11, v11, v21
  v_dot2_f32_bf16 v22, v19, v2, v22
  v_dot2_f32_bf16 v23, v19, v19, v23
  v_add_f32_dpp v20, v20, v20 row_shr:1 row_mask:0xf bank_mask:0xf bound_ctrl:0
  v_add_f32_dpp v21, v21, v21 row_shr:1 row_mask:0xf bank_mask:0xf bound_ctrl:0
  v_add_f32_dpp v22, v22, v22 row_shr:1 row_mask:0xf bank_mask:0xf bound_ctrl:0
  v_add_f32_dpp v23, v23, v23 row_shr:1 row_mask:0xf bank_mask:0xf bound_ctrl:0
  v_add_f32_dpp v20, v20, v20 row_shr:2 row_mask:0xf bank_mask:0xf bound_ctrl:0
  v_add_f32_dpp v21, v21, v21 row_shr:2 row_mask:0xf bank_mask:0xf bound_ctrl:0
  v_add_f32_dpp v22, v22, v22 row_shr:2 row_mask:0xf bank_mask:0xf bound_ctrl:0
  v_add_f32_dpp v23, v23, v23 row_shr:2 row_mask:0xf bank_mask:0xf bound_ctrl:0
  v_add_f32_dpp v20, v20, v20 row_shr:4 row_mask:0xf bank_mask:0xf bound_ctrl:0
  v_add_f32_dpp v21, v21, v21 row_shr:4 row_mask:0xf bank_mask:0xf bound_ctrl:0
  v_add_f32_dpp v22, v22, v22 row_shr:4 row_mask:0xf bank_mask:0xf bound_ctrl:0
  v_add_f32_dpp v23, v23, v23 row_shr:4 row_mask:0xf bank_mask:0xf bound_ctrl:0
  v_add_f32_dpp v20, v20, v20 row_shr:8 row_mask:0xf bank_mask:0xf bound_ctrl:0
  v_add_f32_dpp v21, v21, v21 row_shr:8 row_mask:0xf bank_mask:0xf bound_ctrl:0
  v_add_f32_dpp v22, v22, v22 row_shr:8 row_mask:0xf bank_mask:0xf bound_ctrl:0
  v_add_f32_dpp v23, v23, v23 row_shr:8 row_mask:0xf bank_mask:0xf bound_ctrl:0
  v_add_f32_dpp v20, v20, v20 row_bcast:15 row_mask:0xa bank_mask:0xf
  v_add_f32_dpp v21, v21, v21 row_bcast:15 row_mask:0xa bank_mask:0xf
  v_add_f32_dpp v22, v22, v22 row_bcast:15 row_mask:0xa bank_mask:0xf
  v_add_f32_dpp v23, v23, v23 row_bcast:15 row_mask:0xa bank_mask:0xf
  s_mov_b32 s8, 0x3b124925
  v_pk_mul_f32 v[20:21], v[20:21], s[8:9] op_sel_hi:[1,0]
  v_pk_mul_f32 v[22:23], v[22:23], s[8:9] op_sel_hi:[1,0]
  s_mov_b32 s8, 0x3727c5ac
  v_fma_f32 v21, -v20, v20, v21
  v_fma_f32 v23, -v22, v22, v23
  v_max_f32 v21, 0, v21
  v_max_f32 v23, 0, v23
  v_cvt_pk_bf16_f32 v4, v21, v23
  v_lshrrev_b32 v2, 5, v1
  v_lshlrev_b32 v21, 16, v4
  v_and_b32 v23, 0xffff0000, v4
  v_add_f32 v21, s8, v21
  v_add_f32 v23, s8, v23
  v_cvt_pk_bf16_f32 v4, v21, v23
  s_lshl_b32 s8, s2, 4
  s_lshl_b32 s9, s5, 14
  s_add_u32 s8, s8, s9
  v_lshlrev_b32 v21, 16, v4
  v_and_b32 v23, 0xffff0000, v4
  v_sqrt_f32 v21, v21
  v_sqrt_f32 v23, v23
  s_add_u32 s8, s8, 2162688
  v_cvt_pk_bf16_f32 v8, v20, v22
  v_cvt_pk_bf16_f32 v4, v21, v23
  v_lshl_add_u32 v2, v2, 13, s8
  v_add_u32 v3, 4096, v2
  v_and_b32 v5, 0xffff0000, v4
  v_lshlrev_b32 v4, 16, v4
  v_rcp_f32 v5, v5
  v_rcp_f32 v4, v4
  v_and_b32 v9, 0xffff0000, v8
  v_lshlrev_b32 v8, 16, v8
  v_mov_b32 v6, s50
  v_mov_b32 v7, s50
  v_mov_b32 v10, s50
  v_mov_b32 v11, s50
  v_pk_mul_f32 v[8:9], v[8:9], v[4:5] neg_lo:[1,0] neg_hi:[1,0]
  s_mov_b32 exec_lo, 0x80000000
  s_mov_b32 exec_hi, 0x80000000
  global_store_dwordx4 v2, v[4:7], s[48:49] sc1
  global_store_dwordx4 v3, v[8:11], s[48:49] sc1
  s_mov_b64 exec, -1
L_sp_st:
  s_nop 0
  global_load_dwordx4 v[64:67], v31, s[42:43]
  v_add_u32 v31, 5376, v31
  global_load_dwordx4 v[68:71], v31, s[42:43]
  v_add_u32 v31, 5376, v31
  global_load_dwordx4 v[72:75], v31, s[42:43]
  v_add_u32 v31, 5376, v31
  global_load_dwordx4 v[76:79], v31, s[42:43]
  v_add_u32 v31, 5376, v31
  global_load_dwordx4 v[80:83], v31, s[42:43]
  v_add_u32 v31, 5376, v31
  global_load_dwordx4 v[84:87], v31, s[42:43]
  v_add_u32 v31, 5376, v31
  global_load_dwordx4 v[88:91], v31, s[42:43]
  v_add_u32 v31, 5376, v31
  global_load_dwordx4 v[92:95], v31, s[42:43]
  v_add_u32 v31, 5376, v31
  global_load_dwordx4 v[96:99], v31, s[42:43]
  v_add_u32 v31, 5376, v31
  global_load_dwordx4 v[100:103], v31, s[42:43]
  v_add_u32 v31, 5376, v31
  global_load_dwordx4 v[104:107], v31, s[42:43]
  v_add_u32 v31, 5376, v31
  global_load_dwordx4 v[108:111], v31, s[42:43]
  v_add_u32 v31, 5376, v31
  global_load_dwordx4 v[112:115], v31, s[42:43]
  v_add_u32 v31, 5376, v31
  global_load_dwordx4 v[116:119], v31, s[42:43]
  ds_read_b64 v[34:35], v30 offset:0
  ds_read_b64 v[36:37], v30 offset:8
  ds_read_b64 v[38:39], v30 offset:16
  ds_read_b64 v[40:41], v30 offset:24
  ds_read_b64 v[42:43], v30 offset:32
  ds_read_b64 v[44:45], v30 offset:40
  ds_read_b64 v[46:47], v30 offset:48
  s_waitcnt lgkmcnt(6)
  v_lshlrev_b32 v48, 16, v34
  v_lshlrev_b32 v49, 16, v35
  s_waitcnt lgkmcnt(5)
  v_lshlrev_b32 v50, 16, v36
  v_lshlrev_b32 v51, 16, v37
  s_waitcnt lgkmcnt(4)
  v_lshlrev_b32 v52, 16, v38
  v_lshlrev_b32 v53, 16, v39
  s_waitcnt lgkmcnt(3)
  v_lshlrev_b32 v54, 16, v40
  v_lshlrev_b32 v55, 16, v41
  s_waitcnt lgkmcnt(2)
  v_lshlrev_b32 v56, 16, v42
  v_lshlrev_b32 v57, 16, v43
  s_waitcnt lgkmcnt(1)
  v_lshlrev_b32 v58, 16, v44
  v_lshlrev_b32 v59, 16, v45
  s_waitcnt lgkmcnt(0)
  v_lshlrev_b32 v60, 16, v46
  v_lshlrev_b32 v61, 16, v47
  s_waitcnt vmcnt(13)
  v_dot2_f32_bf16 v176, v64, v34, 0
  v_dot2_f32_bf16 v177, v64, v48, 0
  v_dot2_f32_bf16 v178, v65, v34, 0
  v_dot2_f32_bf16 v179, v65, v48, 0
  v_dot2_f32_bf16 v180, v66, v34, 0
  v_dot2_f32_bf16 v181, v66, v48, 0
  v_dot2_f32_bf16 v182, v67, v34, 0
  v_dot2_f32_bf16 v183, v67, v48, 0
  s_waitcnt vmcnt(12)
  s_nop 0
  v_dot2_f32_bf16 v176, v68, v35, v176
  v_dot2_f32_bf16 v177, v68, v49, v177
  v_dot2_f32_bf16 v178, v69, v35, v178
  v_dot2_f32_bf16 v179, v69, v49, v179
  v_dot2_f32_bf16 v180, v70, v35, v180
  v_dot2_f32_bf16 v181, v70, v49, v181
  v_dot2_f32_bf16 v182, v71, v35, v182
  v_dot2_f32_bf16 v183, v71, v49, v183
  s_waitcnt vmcnt(11)
  s_nop 0
  v_dot2_f32_bf16 v176, v72, v36, v176
  v_dot2_f32_bf16 v177, v72, v50, v177
  v_dot2_f32_bf16 v178, v73, v36, v178
  v_dot2_f32_bf16 v179, v73, v50, v179
  v_dot2_f32_bf16 v180, v74, v36, v180
  v_dot2_f32_bf16 v181, v74, v50, v181
  v_dot2_f32_bf16 v182, v75, v36, v182
  v_dot2_f32_bf16 v183, v75, v50, v183
  s_waitcnt vmcnt(10)
  s_nop 0
  v_dot2_f32_bf16 v176, v76, v37, v176
  v_dot2_f32_bf16 v177, v76, v51, v177
  v_dot2_f32_bf16 v178, v77, v37, v178
  v_dot2_f32_bf16 v179, v77, v51, v179
  v_dot2_f32_bf16 v180, v78, v37, v180
  v_dot2_f32_bf16 v181, v78, v51, v181
  v_dot2_f32_bf16 v182, v79, v37, v182
  v_dot2_f32_bf16 v183, v79, v51, v183
  s_waitcnt vmcnt(9)
  s_nop 0
  v_dot2_f32_bf16 v176, v80, v38, v176
  v_dot2_f32_bf16 v177, v80, v52, v177
  v_dot2_f32_bf16 v178, v81, v38, v178
  v_dot2_f32_bf16 v179, v81, v52, v179
  v_dot2_f32_bf16 v180, v82, v38, v180
  v_dot2_f32_bf16 v181, v82, v52, v181
  v_dot2_f32_bf16 v182, v83, v38, v182
  v_dot2_f32_bf16 v183, v83, v52, v183
  s_waitcnt vmcnt(8)
  s_nop 0
  v_dot2_f32_bf16 v176, v84, v39, v176
  v_dot2_f32_bf16 v177, v84, v53, v177
  v_dot2_f32_bf16 v178, v85, v39, v178
  v_dot2_f32_bf16 v179, v85, v53, v179
  v_dot2_f32_bf16 v180, v86, v39, v180
  v_dot2_f32_bf16 v181, v86, v53, v181
  v_dot2_f32_bf16 v182, v87, v39, v182
  v_dot2_f32_bf16 v183, v87, v53, v183
  s_waitcnt vmcnt(7)
  s_nop 0
  v_dot2_f32_bf16 v176, v88, v40, v176
  v_dot2_f32_bf16 v177, v88, v54, v177
  v_dot2_f32_bf16 v178, v89, v40, v178
  v_dot2_f32_bf16 v179, v89, v54, v179
  v_dot2_f32_bf16 v180, v90, v40, v180
  v_dot2_f32_bf16 v181, v90, v54, v181
  v_dot2_f32_bf16 v182, v91, v40, v182
  v_dot2_f32_bf16 v183, v91, v54, v183
  s_waitcnt vmcnt(6)
  s_nop 0
  v_dot2_f32_bf16 v176, v92, v41, v176
  v_dot2_f32_bf16 v177, v92, v55, v177
  v_dot2_f32_bf16 v178, v93, v41, v178
  v_dot2_f32_bf16 v179, v93, v55, v179
  v_dot2_f32_bf16 v180, v94, v41, v180
  v_dot2_f32_bf16 v181, v94, v55, v181
  v_dot2_f32_bf16 v182, v95, v41, v182
  v_dot2_f32_bf16 v183, v95, v55, v183
  s_waitcnt vmcnt(5)
  s_nop 0
  v_dot2_f32_bf16 v176, v96, v42, v176
  v_dot2_f32_bf16 v177, v96, v56, v177
  v_dot2_f32_bf16 v178, v97, v42, v178
  v_dot2_f32_bf16 v179, v97, v56, v179
  v_dot2_f32_bf16 v180, v98, v42, v180
  v_dot2_f32_bf16 v181, v98, v56, v181
  v_dot2_f32_bf16 v182, v99, v42, v182
  v_dot2_f32_bf16 v183, v99, v56, v183
  s_waitcnt vmcnt(4)
  s_nop 0
  v_dot2_f32_bf16 v176, v100, v43, v176
  v_dot2_f32_bf16 v177, v100, v57, v177
  v_dot2_f32_bf16 v178, v101, v43, v178
  v_dot2_f32_bf16 v179, v101, v57, v179
  v_dot2_f32_bf16 v180, v102, v43, v180
  v_dot2_f32_bf16 v181, v102, v57, v181
  v_dot2_f32_bf16 v182, v103, v43, v182
  v_dot2_f32_bf16 v183, v103, v57, v183
  s_waitcnt vmcnt(3)
  s_nop 0
  v_dot2_f32_bf16 v176, v104, v44, v176
  v_dot2_f32_bf16 v177, v104, v58, v177
  v_dot2_f32_bf16 v178, v105, v44, v178
  v_dot2_f32_bf16 v179, v105, v58, v179
  v_dot2_f32_bf16 v180, v106, v44, v180
  v_dot2_f32_bf16 v181, v106, v58, v181
  v_dot2_f32_bf16 v182, v107, v44, v182
  v_dot2_f32_bf16 v183, v107, v58, v183
  s_waitcnt vmcnt(2)
  s_nop 0
  v_dot2_f32_bf16 v176, v108, v45, v176
  v_dot2_f32_bf16 v177, v108, v59, v177
  v_dot2_f32_bf16 v178, v109, v45, v178
  v_dot2_f32_bf16 v179, v109, v59, v179
  v_dot2_f32_bf16 v180, v110, v45, v180
  v_dot2_f32_bf16 v181, v110, v59, v181
  v_dot2_f32_bf16 v182, v111, v45, v182
  v_dot2_f32_bf16 v183, v111, v59, v183
  s_waitcnt vmcnt(1)
  s_nop 0
  v_dot2_f32_bf16 v176, v112, v46, v176
  v_dot2_f32_bf16 v177, v112, v60, v177
  v_dot2_f32_bf16 v178, v113, v46, v178
  v_dot2_f32_bf16 v179, v113, v60, v179
  v_dot2_f32_bf16 v180, v114, v46, v180
  v_dot2_f32_bf16 v181, v114, v60, v181
  v_dot2_f32_bf16 v182, v115, v46, v182
  v_dot2_f32_bf16 v183, v115, v60, v183
  s_waitcnt vmcnt(0)
  s_nop 0
  v_dot2_f32_bf16 v176, v116, v47, v176
  v_dot2_f32_bf16 v177, v116, v61, v177
  v_dot2_f32_bf16 v178, v117, v47, v178
  v_dot2_f32_bf16 v179, v117, v61, v179
  v_dot2_f32_bf16 v180, v118, v47, v180
  v_dot2_f32_bf16 v181, v118, v61, v181
  v_dot2_f32_bf16 v182, v119, v47, v182
  v_dot2_f32_bf16 v183, v119, v61, v183
  ds_write_b128 v29, v[176:179] offset:10240
  ds_write_b128 v29, v[180:183] offset:10256
  s_waitcnt lgkmcnt(0)
  s_barrier
  s_cmp_lg_u32 s57, 0
  s_cbranch_scc1 L_spare_red1
  ds_read_b64 v[204:205], v202 offset:10240
  ds_read_b64 v[206:207], v202 offset:10496
  ds_read_b64 v[208:209], v202 offset:10752
  ds_read_b64 v[210:211], v202 offset:11008
  ds_read_b64 v[212:213], v202 offset:11264
  ds_read_b64 v[214:215], v202 offset:11520
  ds_read_b64 v[216:217], v202 offset:11776
  ds_read_b64 v[218:219], v202 offset:12032
  ds_read_b64 v[220:221], v202 offset:12288
  ds_read_b64 v[222:223], v202 offset:12544
  ds_read_b64 v[224:225], v202 offset:12800
  ds_read_b64 v[226:227], v202 offset:13056
  ds_read_b64 v[228:229], v202 offset:13312
  ds_read_b64 v[230:231], v202 offset:13568
  ds_read_b64 v[232:233], v202 offset:13824
  ds_read_b64 v[234:235], v202 offset:14080
  s_waitcnt lgkmcnt(14)
  v_pk_add_f32 v[204:205], v[204:205], v[206:207]
  s_waitcnt lgkmcnt(13)
  v_pk_add_f32 v[204:205], v[204:205], v[208:209]
  s_waitcnt lgkmcnt(12)
  v_pk_add_f32 v[204:205], v[204:205], v[210:211]
  s_waitcnt lgkmcnt(11)
  v_pk_add_f32 v[204:205], v[204:205], v[212:213]
  s_waitcnt lgkmcnt(10)
  v_pk_add_f32 v[204:205], v[204:205], v[214:215]
  s_waitcnt lgkmcnt(9)
  v_pk_add_f32 v[204:205], v[204:205], v[216:217]
  s_waitcnt lgkmcnt(8)
  v_pk_add_f32 v[204:205], v[204:205], v[218:219]
  s_waitcnt lgkmcnt(7)
  v_pk_add_f32 v[204:205], v[204:205], v[220:221]
  s_waitcnt lgkmcnt(6)
  v_pk_add_f32 v[204:205], v[204:205], v[222:223]
  s_waitcnt lgkmcnt(5)
  v_pk_add_f32 v[204:205], v[204:205], v[224:225]
  s_waitcnt lgkmcnt(4)
  v_pk_add_f32 v[204:205], v[204:205], v[226:227]
  s_waitcnt lgkmcnt(3)
  v_pk_add_f32 v[204:205], v[204:205], v[228:229]
  s_waitcnt lgkmcnt(2)
  v_pk_add_f32 v[204:205], v[204:205], v[230:231]
  s_waitcnt lgkmcnt(1)
  v_pk_add_f32 v[204:205], v[204:205], v[232:233]
  s_waitcnt lgkmcnt(0)
  v_pk_add_f32 v[204:205], v[204:205], v[234:235]
  v_mov_b32 v206, v204
  v_mov_b32 v207, v205
  s_nop 0
  v_permlane32_swap_b32 v204, v206
  v_permlane32_swap_b32 v205, v207
  v_pk_add_f32 v[204:205], v[204:205], v[206:207]
  v_cvt_pk_bf16_f32 v204, v204, v205
  v_mov_b32 v205, s50
  s_lshl_b32 s11, s10, 8
  s_add_u32 s11, s11, 24064
  v_add_u32 v203, s11, v201
  s_mov_b32 exec_hi, 0
  global_store_dwordx2 v203, v[204:205], s[48:49] sc1
  s_mov_b32 exec_hi, -1
L_spare_red1:
  s_branch L_spare_end
L_spare_idle:
  s_lshl_b32 s4, s2, 3
  s_lshl_b32 s6, s5, 2
  s_add_u32 s4, s4, s6
  s_mul_i32 s6, s4, 896
  v_lshrrev_b32 v2, 5, v1
  v_mul_u32_u24 v2, 768, v2
  v_lshl_add_u32 v3, v1, 5, s6
  v_add_u32 v3, v2, v3
  v_mov_b32 v4, 0
  v_mov_b32 v5, 0
  v_mov_b32 v6, 0
  v_mov_b32 v7, 0
  v_mov_b32 v8, 0
  v_mov_b32 v9, 0
  v_mov_b32 v10, 0
  v_mov_b32 v11, 0
  v_mov_b32 v12, 0
  v_mov_b32 v13, 0
  v_mov_b32 v14, 0
  v_mov_b32 v15, 0
  v_mov_b32 v16, 0
  v_mov_b32 v17, 0
  v_mov_b32 v18, 0
  v_mov_b32_e64 v19, 0
  s_mov_b32 exec_lo, 0x0fffffff
  s_mov_b32 exec_hi, 0x0fffffff
  global_load_dwordx4 v[4:7], v3, s[16:17]
  global_load_dwordx4 v[8:11], v3, s[16:17] offset:16
  global_load_dwordx4 v[12:15], v3, s[16:17] offset:896
  global_load_dwordx4 v[16:19], v3, s[16:17] offset:912
  s_mov_b64 exec, -1
  s_waitcnt lgkmcnt(0)
  s_add_u32 s51, s51, 1
  s_mul_i32 s50, s51, 0x9E3779B1
  s_add_u32 s50, s50, 0x7F4A7C15
  s_barrier
  v_mov_b32 v2, 0x3f803f80
  s_waitcnt vmcnt(3)
  v_dot2_f32_bf16 v20, v4, v2, 0
  v_dot2_f32_bf16 v21, v4, v4, 0
  s_waitcnt vmcnt(1)
  v_dot2_f32_bf16 v22, v12, v2, 0
  v_dot2_f32_bf16 v23, v12, v12, 0
  v_dot2_f32_bf16 v20, v5, v2, v20
  v_dot2_f32_bf16 v21, v5, v5, v21
  v_dot2_f32_bf16 v22, v13, v2, v22
  v_dot2_f32_bf16 v23, v13, v13, v23
  v_dot2_f32_bf16 v20, v6, v2, v20
  v_dot2_f32_bf16 v21, v6, v6, v21
  v_dot2_f32_bf16 v22, v14, v2, v22
  v_dot2_f32_bf16 v23, v14, v14, v23
  v_dot2_f32_bf16 v20, v7, v2, v20
  v_dot2_f32_bf16 v21, v7, v7, v21
  v_dot2_f32_bf16 v22, v15, v2, v22
  v_dot2_f32_bf16 v23, v15, v15, v23
  v_dot2_f32_bf16 v20, v8, v2, v20
  v_dot2_f32_bf16 v21, v8, v8, v21
  s_waitcnt vmcnt(0)
  s_nop 0
  v_dot2_f32_bf16 v22, v16, v2, v22
  v_dot2_f32_bf16 v23, v16, v16, v23
  v_dot2_f32_bf16 v20, v9, v2, v20
  v_dot2_f32_bf16 v21, v9, v9, v21
  v_dot2_f32_bf16 v22, v17, v2, v22
  v_dot2_f32_bf16 v23, v17, v17, v23
  v_dot2_f32_bf16 v20, v10, v2, v20
  v_dot2_f32_bf16 v21, v10, v10, v21
  v_dot2_f32_bf16 v22, v18, v2, v22
  v_dot2_f32_bf16 v23, v18, v18, v23
  v_dot2_f32_bf16 v20, v11, v2, v20
  v_dot2_f32_bf16 v21, v11, v11, v21
  v_dot2_f32_bf16 v22, v19, v2, v22
  v_dot2_f32_bf16 v23, v19, v19, v23
  v_add_f32_dpp v20, v20, v20 row_shr:1 row_mask:0xf bank_mask:0xf bound_ctrl:0
  v_add_f32_dpp v21, v21, v21 row_shr:1 row_mask:0xf bank_mask:0xf bound_ctrl:0
  v_add_f32_dpp v22, v22, v22 row_shr:1 row_mask:0xf bank_mask:0xf bound_ctrl:0
  v_add_f32_dpp v23, v23, v23 row_shr:1 row_mask:0xf bank_mask:0xf bound_ctrl:0
  v_add_f32_dpp v20, v20, v20 row_shr:2 row_mask:0xf bank_mask:0xf bound_ctrl:0
  v_add_f32_dpp v21, v21, v21 row_shr:2 row_mask:0xf bank_mask:0xf bound_ctrl:0
  v_add_f32_dpp v22, v22, v22 row_shr:2 row_mask:0xf bank_mask:0xf bound_ctrl:0
  v_add_f32_dpp v23, v23, v23 row_shr:2 row_mask:0xf bank_mask:0xf bound_ctrl:0
  v_add_f32_dpp v20, v20, v20 row_shr:4 row_mask:0xf bank_mask:0xf bound_ctrl:0
  v_add_f32_dpp v21, v21, v21 row_shr:4 row_mask:0xf bank_mask:0xf bound_ctrl:0
  v_add_f32_dpp v22, v22, v22 row_shr:4 row_mask:0xf bank_mask:0xf bound_ctrl:0
  v_add_f32_dpp v23, v23, v23 row_shr:4 row_mask:0xf bank_mask:0xf bound_ctrl:0
  v_add_f32_dpp v20, v20, v20 row_shr:8 row_mask:0xf bank_mask:0xf bound_ctrl:0
  v_add_f32_dpp v21, v21, v21 row_shr:8 row_mask:0xf bank_mask:0xf bound_ctrl:0
  v_add_f32_dpp v22, v22, v22 row_shr:8 row_mask:0xf bank_mask:0xf bound_ctrl:0
  v_add_f32_dpp v23, v23, v23 row_shr:8 row_mask:0xf bank_mask:0xf bound_ctrl:0
  v_add_f32_dpp v20, v20, v20 row_bcast:15 row_mask:0xa bank_mask:0xf
  v_add_f32_dpp v21, v21, v21 row_bcast:15 row_mask:0xa bank_mask:0xf
  v_add_f32_dpp v22, v22, v22 row_bcast:15 row_mask:0xa bank_mask:0xf
  v_add_f32_dpp v23, v23, v23 row_bcast:15 row_mask:0xa bank_mask:0xf
  s_mov_b32 s8, 0x3b124925
  v_pk_mul_f32 v[20:21], v[20:21], s[8:9] op_sel_hi:[1,0]
  v_pk_mul_f32 v[22:23], v[22:23], s[8:9] op_sel_hi:[1,0]
  s_mov_b32 s8, 0x3727c5ac
  v_fma_f32 v21, -v20, v20, v21
  v_fma_f32 v23, -v22, v22, v23
  v_max_f32 v21, 0, v21
  v_max_f32 v23, 0, v23
  v_cvt_pk_bf16_f32 v4, v21, v23
  v_lshrrev_b32 v2, 5, v1
  v_lshlrev_b32 v21, 16, v4
  v_and_b32 v23, 0xffff0000, v4
  v_add_f32 v21, s8, v21
  v_add_f32 v23, s8, v23
  v_cvt_pk_bf16_f32 v4, v21, v23
  s_lshl_b32 s8, s2, 4
  s_lshl_b32 s9, s5, 14
  s_add_u32 s8, s8, s9
  v_lshlrev_b32 v21, 16, v4
  v_and_b32 v23, 0xffff0000, v4
  v_sqrt_f32 v21, v21
  v_sqrt_f32 v23, v23
  s_add_u32 s8, s8, 2162688
  v_cvt_pk_bf16_f32 v8, v20, v22
  v_cvt_pk_bf16_f32 v4, v21, v23
  v_lshl_add_u32 v2, v2, 13, s8
  v_add_u32 v3, 4096, v2
  v_and_b32 v5, 0xffff0000, v4
  v_lshlrev_b32 v4, 16, v4
  v_rcp_f32 v5, v5
  v_rcp_f32 v4, v4
  v_and_b32 v9, 0xffff0000, v8
  v_lshlrev_b32 v8, 16, v8
  v_mov_b32 v6, s50
  v_mov_b32 v7, s50
  v_mov_b32 v10, s50
  v_mov_b32 v11, s50
  v_pk_mul_f32 v[8:9], v[8:9], v[4:5] neg_lo:[1,0] neg_hi:[1,0]
  s_mov_b32 exec_lo, 0x80000000
  s_mov_b32 exec_hi, 0x80000000
  global_store_dwordx4 v2, v[4:7], s[48:49] sc1
  global_store_dwordx4 v3, v[8:11], s[48:49] sc1
  s_mov_b64 exec, -1
L_spare_end:
  s_endpgm
L_codeend:
.section .rodata,"a"
.p2align 6
.amdhsa_kernel adaLN_cond__ssm_conv_s4__dense_activation_silu__prompt_kernel
  .amdhsa_next_free_vgpr 512
  .amdhsa_next_free_sgpr 102
  .amdhsa_accum_offset 256
  .amdhsa_group_segment_fixed_size 0
  .amdhsa_kernarg_size 136
  .amdhsa_user_sgpr_count 2
  .amdhsa_user_sgpr_kernarg_segment_ptr 1
  .amdhsa_system_sgpr_workgroup_id_x 1
.end_amdhsa_kernel
```
